```python
import torch

def _softmax(x, axis=-1):
    return torch.softmax(x, dim=axis)

def _gelu(x):
    return torch.nn.functional.gelu(x, approximate='tanh')

def _silu(x):
    return torch.nn.functional.silu(x)

def _sigmoid(x):
    return torch.sigmoid(x)

def _layernorm(x, axis=-1, eps=1e-05):
    m = x.mean(dim=axis, keepdim=True)
    v = x.var(dim=axis, keepdim=True, unbiased=False)
    return (x - m) / torch.sqrt(v + eps)

def _scatter_add(tgt, idx, src, axis=0):
    return tgt.clone().index_add_(axis, idx, src)

def _segment_sum(src, seg, n):
    out = torch.zeros((n,) + src.shape[1:], dtype=src.dtype)
    return out.index_add_(0, seg, src)

def _pad(x, pw):
    flat = tuple((v for pair in reversed(pw) for v in pair))
    return torch.nn.functional.pad(x, flat)
kernel_name = 'adaLN_cond__ssm_conv_h3__dense_activation_silu__prompt'

def setup_inputs():

    _w = lambda a: (lambda t: t.to(torch.bfloat16) if t.is_floating_point() else t)(torch.as_tensor(a))

    def _A_setup():
        B, S, D = (1, 2048, 448)
        ks = 4
        return {'q': _w((lambda *s: torch.randn(*s, dtype=torch.bfloat16) * 0.05)(B, S, D)), 'k': _w((lambda *s: torch.randn(*s, dtype=torch.bfloat16) * 0.8)(B, S, D)), 'v': _w((lambda *s: torch.randn(*s, dtype=torch.bfloat16) * 0.8)(B, S, D)), 'shift_k': _w((lambda *s: torch.randn(*s, dtype=torch.bfloat16) * 0.8)(D, ks) * 0.5), 'ssm_k': _w((lambda *s: torch.randn(*s, dtype=torch.bfloat16) * 0.8)(D, S) * (1.0 / S ** 0.5)), 'ssm_D': _w((lambda *s: torch.randn(*s, dtype=torch.bfloat16) * 0.8)(D))}
    _A_in = _A_setup()

    def _B_setup():
        B, S, D, F = (1, 2048, 448, 1792)
        return {'x': _w((lambda *s: torch.randn(*s, dtype=torch.bfloat16) * 0.05)(B, S, D)), 'w1': _w((lambda *s: torch.randn(*s, dtype=torch.bfloat16) * 3.2)(D, F) * D ** (-0.5)), 'w2': _w((lambda *s: torch.randn(*s, dtype=torch.bfloat16) * 0.8)(F, D) * F ** (-0.5))}
    _B_in = _B_setup()
    return {'A_q': _A_in['q'], 'A_k': _A_in['k'], 'A_v': _A_in['v'], 'A_shift_k': _A_in['shift_k'], 'A_ssm_k': _A_in['ssm_k'], 'A_ssm_D': _A_in['ssm_D'], 'B_x': _B_in['x'], 'B_w1': _B_in['w1'], 'B_w2': _B_in['w2'], 'c': _w((lambda *s: torch.randn(*s, dtype=torch.bfloat16) * 0.2)(1, 448) * 8.0), 'w_mod': _w((lambda *s: torch.randn(*s, dtype=torch.bfloat16) * 0.2)(448, 6 * 448) * 448 ** (-0.5) * 8.0)}

def reference(A_q, A_k, A_v, A_shift_k, A_ssm_k, A_ssm_D, B_x, B_w1, B_w2, c, w_mod):

    def _A_ref(q, k, v, shift_k, ssm_k, ssm_D):
        B, S, D = q.shape
        ks = shift_k.shape[-1]
        k_pad = _pad(k, ((0, 0), (ks - 1, 0), (0, 0)))
        k_shift = torch.zeros_like(k)
        for t in range(ks):
            k_shift = k_shift + k_pad[:, t:t + S, :] * shift_k[:, ks - 1 - t][None, None, :]
        kv = k_shift * v
        L = 2 * S
        kv_pad = _pad(kv, ((0, 0), (0, S), (0, 0)))
        kf_pad = _pad(ssm_k, ((0, 0), (0, S)))
        kv_f = (lambda x, axes=(-2, -1): torch.fft.rfft2(x.float(), dim=axes))(kv_pad[:, None, :, :], axes=(1, 2))
        kf_f = (lambda x, axes=(-2, -1): torch.fft.rfft2(x.float(), dim=axes))(kf_pad[:, None, :], axes=(1, 2))
        kf_f = (lambda x, *d: x.permute(*d))(kf_f, 1, 2, 0)
        y_f = kv_f * kf_f[None, :, :, :]
        y = (lambda x, s, axes=(-2, -1): torch.fft.irfft2(x, s=s, dim=axes).to(torch.bfloat16))(y_f, (1, L), axes=(1, 2))[:, 0, :S, :]
        y = y + kv * ssm_D[None, None, :]
        return q * y

    def _B_ref(x, w1, w2):
        h = torch.einsum('bsd,df->bsf', x, w1)
        h = _silu(h)
        out = torch.einsum('bsf,fd->bsd', h, w2)
        return out
    x = A_q
    mod = (_silu(c) @ w_mod).reshape(c.shape[0], 6, 1, -1)
    sa, ca, ga, sb, cb, gb = (mod[:, 0].clone(), mod[:, 1].clone(), mod[:, 2].clone(), mod[:, 3].clone(), mod[:, 4].clone(), mod[:, 5].clone())
    h = _layernorm(x, axis=-1) * (1 + ca) + sa
    x = x + ga * _A_ref(h, A_k, A_v, A_shift_k, A_ssm_k, A_ssm_D)
    h = _layernorm(x, axis=-1) * (1 + cb) + sb
    x = x + gb * _B_ref(h, B_w1, B_w2)
    return x
```

```asm
; @launch grid=(224,1,1) block=(256,1,1) lds=137984
.amdgcn_target "amdgcn-amd-amdhsa--gfx950"
.text
.globl adaLN_cond__ssm_conv_h3__dense_activation_silu__prompt_kernel
.p2align 8
.type adaLN_cond__ssm_conv_h3__dense_activation_silu__prompt_kernel,@function
adaLN_cond__ssm_conv_h3__dense_activation_silu__prompt_kernel:
    s_cmp_ge_u32 s2, 224
    s_cbranch_scc1 L_exit
    s_load_dwordx16 s[8:23], s[0:1], 0
    s_load_dwordx8 s[24:31], s[0:1], 64
    s_load_dwordx4 s[32:35], s[0:1], 96
    s_getpc_b64 s[100:101]
L_pc:
    v_lshlrev_b32 v253, 7, v0
    v_min_u32 v253, L_code_end-L_pc-4, v253
    global_load_dword v254, v253, s[100:101]
    v_lshrrev_b32 v2, 6, v0
    v_and_b32 v1, 63, v0
    s_and_b32 s57, s2, 7
    s_lshr_b32 s58, s2, 3
    v_readfirstlane_b32 s6, v2
    s_mov_b32 s80, 0xffff0000
    s_mov_b32 s81, 0x05040100
    s_mov_b32 s82, 0x07060302
    s_mov_b32 s94, s58
    s_mul_i32 s59, s94, 37
    s_lshr_b32 s59, s59, 8
    s_mul_i32 s60, s59, 7
    s_sub_u32 s5, s94, s60
    s_lshl_b32 s4, s57, 2
    s_add_u32 s4, s4, s59
    s_lshl_b32 s7, s5, 5
    s_add_u32 s7, s7, s4
    s_waitcnt lgkmcnt(0)
    s_mov_b32 s36, s34
    s_mov_b32 s37, s35
    s_mov_b32 s38, 16400384
    s_mov_b32 s39, 0x00020000
    s_load_dword s56, s[34:35], 0
    s_mul_i32 s93, s57, 28
    s_add_u32 s93, s93, s94
    v_and_b32 v2, 7, v1
    v_lshrrev_b32 v3, 3, v1
    s_lshl_b32 s57, s4, 6
    s_lshl_b32 s58, s6, 4
    s_add_u32 s58, s57, s58
    v_lshl_add_u32 v5, v3, 1, s58
    v_mul_u32_u24 v5, 896, v5
    v_lshl_add_u32 v5, v2, 4, v5
    s_lshl_b32 s59, s5, 7
    v_add_u32 v5, s59, v5
    v_subrev_u32 v6, 2688, v5
    v_subrev_u32 v7, 1792, v5
    v_subrev_u32 v8, 896, v5
    v_add_u32 v9, 896, v5
    s_mov_b32 s40, s10
    s_mov_b32 s41, s11
    s_mov_b32 s42, 1835008
    s_mov_b32 s43, 0x00020000
    s_mov_b32 s44, s12
    s_mov_b32 s45, s13
    s_mov_b32 s46, 1835008
    s_mov_b32 s47, 0x00020000
    buffer_load_dwordx4 v[16:19], v6, s[40:43], 0 offen
    buffer_load_dwordx4 v[20:23], v7, s[40:43], 0 offen
    buffer_load_dwordx4 v[24:27], v8, s[40:43], 0 offen
    buffer_load_dwordx4 v[28:31], v5, s[40:43], 0 offen
    buffer_load_dwordx4 v[32:35], v9, s[40:43], 0 offen
    buffer_load_dwordx4 v[36:39], v5, s[44:47], 0 offen offset:0
    buffer_load_dwordx4 v[40:43], v5, s[44:47], 0 offen offset:896
    s_mov_b32 s48, s14
    s_mov_b32 s49, s15
    s_mov_b32 s50, 3584
    s_mov_b32 s51, 0x00020000
    s_lshl_b32 s60, s5, 9
    v_lshl_add_u32 v10, v2, 6, s60
    buffer_load_dwordx4 v[44:47], v10, s[48:51], 0 offen offset:0
    buffer_load_dwordx4 v[48:51], v10, s[48:51], 0 offen offset:16
    buffer_load_dwordx4 v[52:55], v10, s[48:51], 0 offen offset:32
    buffer_load_dwordx4 v[56:59], v10, s[48:51], 0 offen offset:48
    s_mov_b32 s40, s8
    s_mov_b32 s41, s9
    s_mov_b32 s42, 1835008
    s_mov_b32 s43, 0x00020000
    buffer_load_dwordx4 v[60:63], v5, s[40:43], 0 offen offset:0
    buffer_load_dwordx4 v[64:67], v5, s[40:43], 0 offen offset:896
    s_lshl_b32 s70, s5, 3
    s_add_u32 s69, s57, s70
    s_lshl_b32 s70, s6, 2
    s_add_u32 s69, s69, s70
    v_lshrrev_b32 v13, 4, v1
    v_add_u32 v13, s69, v13
    v_mul_u32_u24 v11, 896, v13
    v_and_b32 v12, 15, v1
    v_lshl_add_u32 v11, v12, 4, v11
    v_cmp_gt_u32 vcc, 8, v12
    v_add_u32 v12, 768, v11
    v_mov_b32 v15, -1
    v_cndmask_b32 v12, v15, v12, vcc
    buffer_load_dwordx4 v[68:71], v11, s[40:43], 0 offen offset:0
    buffer_load_dwordx4 v[72:75], v11, s[40:43], 0 offen offset:256
    buffer_load_dwordx4 v[76:79], v11, s[40:43], 0 offen offset:512
    buffer_load_dwordx4 v[80:83], v12, s[40:43], 0 offen
    s_mov_b32 s44, s28
    s_mov_b32 s45, s29
    s_mov_b32 s46, 2408448
    s_mov_b32 s47, 0x00020000
    s_mov_b32 s48, s26
    s_mov_b32 s49, s27
    s_mov_b32 s50, 896
    s_mov_b32 s51, 0x00020000
    s_mul_i32 s62, s93, 1561
    s_lshr_b32 s62, s62, 16
    s_mul_i32 s78, s62, 42
    s_sub_u32 s78, s93, s78
    s_mul_i32 s69, s6, 24
    v_lshrrev_b32 v108, 3, v1
    v_add_u32 v108, s69, v108
    s_mul_i32 s70, s62, 90
    v_add_u32 v109, s70, v108
    v_lshlrev_b32 v117, 1, v109
    v_mul_u32_u24 v116, 5376, v109
    v_and_b32 v110, 7, v1
    v_lshl_add_u32 v116, v110, 4, v116
    s_lshl_b32 s70, s78, 7
    v_add_u32 v116, s70, v116
    v_cmp_gt_u32 vcc, 74, v108
    v_add_u32 v111, 86016, v116
    v_mov_b32 v112, 0x80000000
    v_add_u32 v113, 43008, v116
    v_cndmask_b32 v111, v112, v111, vcc
    buffer_load_ushort v96, v117, s[48:51], 0 offen offset:0
    buffer_load_ushort v97, v117, s[48:51], 0 offen offset:16
    buffer_load_ushort v98, v117, s[48:51], 0 offen offset:32
    buffer_load_dwordx4 v[84:87], v116, s[44:47], 0 offen
    buffer_load_dwordx4 v[88:91], v113, s[44:47], 0 offen
    buffer_load_dwordx4 v[92:95], v111, s[44:47], 0 offen
    s_mul_i32 s61, s4, 7
    s_add_u32 s61, s61, s5
    s_lshr_b32 s69, s61, 2
    s_and_b32 s70, s61, 3
    s_mul_i32 s63, s69, 57344
    s_mul_i32 s71, s70, 896
    s_add_u32 s63, s63, s71
    s_mul_i32 s71, s70, 14
    s_add_u32 s71, s71, s6
    s_mul_i32 s71, s71, 28
    s_add_u32 s67, s71, s69
    s_lshl_b32 s67, s67, 10
    s_add_u32 s67, s67, 5783552
    s_sub_u32 s73, s61, 112
    s_mul_i32 s76, s73, 14336
    s_mul_i32 s74, s73, 147
    s_lshr_b32 s74, s74, 12
    s_mul_i32 s75, s74, 28
    s_sub_u32 s75, s73, s75
    s_mul_i32 s77, s74, 56
    s_lshl_b32 s75, s75, 1
    s_add_u32 s77, s77, s75
    s_lshr_b32 s74, s6, 1
    s_mul_i32 s74, s74, 224
    s_add_u32 s77, s77, s74
    s_and_b32 s74, s6, 1
    s_add_u32 s77, s77, s74
    s_lshl_b32 s77, s77, 10
    s_add_u32 s77, s77, 7389184
    s_cmp_ge_u32 s61, 112
    s_cselect_b32 s63, s76, s63
    s_cselect_b32 s67, s77, s67
    s_mov_b32 s64, 3584
    s_cselect_b32 s64, 896, s64
    s_cselect_b32 s65, 4, 8
    s_mov_b32 s66, 4352
    s_cselect_b32 s66, 8704, s66
    s_mov_b32 s68, 114688
    s_cselect_b32 s68, 458752, s68
    s_cselect_b32 s52, s24, s22
    s_cselect_b32 s53, s25, s23
    s_mov_b32 s54, 1605632
    s_mov_b32 s55, 0x00020000
    s_lshl_b32 s69, s6, 2
    s_mul_i32 s69, s69, s64
    s_add_u32 s63, s63, s69
    v_lshlrev_b32 v4, 4, v1
    v_add_u32 v14, s63, v4
    s_lshl_b32 s69, s7, 13
    s_add_u32 s44, s16, s69
    s_addc_u32 s45, s17, 0
    s_mov_b32 s46, 4096
    s_mov_b32 s47, 0x00020000
    s_add_u32 s69, s69, 4096
    s_add_u32 s48, s16, s69
    s_addc_u32 s49, s17, 0
    s_mov_b32 s50, 4096
    s_mov_b32 s51, 0x00020000
    v_lshlrev_b32 v132, 4, v0
    v_subrev_u32 v133, 16, v132
    v_subrev_u32 v132, 32, v132
    v_and_b32 v134, 1, v1
    v_lshlrev_b32 v134, 4, v134
    v_add_u32 v135, 4080, v134
    v_add_u32 v143, 61440, v134
    v_add_u32 v134, 4064, v134
    v_lshlrev_b32 v142, 4, v0
    v_add_u32 v142, 57344, v142
    v_mul_u32_u24 v136, 1088, v2
    v_lshl_add_u32 v136, v3, 3, v136
    s_lshl_b32 s69, s6, 6
    v_add_u32 v136, s69, v136
    s_mul_i32 s70, s6, 4352
    v_add_u32 v137, s70, v4
    v_lshrrev_b32 v139, 4, v0
    v_mul_u32_u24 v138, 272, v139
    v_and_b32 v15, 15, v0
    v_lshl_add_u32 v138, v15, 4, v138
    v_lshlrev_b32 v139, 13, v139
    v_lshl_add_u32 v139, v15, 4, v139
    v_lshrrev_b32 v140, 5, v1
    v_mul_lo_u32 v140, v140, s65
    v_bfe_u32 v15, v1, 2, 2
    v_add_u32 v140, v140, v15
    v_mul_u32_u24 v140, 1088, v140
    v_bfe_u32 v15, v1, 4, 1
    v_lshl_add_u32 v140, v15, 5, v140
    v_and_b32 v15, 3, v1
    v_lshl_add_u32 v140, v15, 3, v140
    v_add_u32 v140, s69, v140
    v_add_u32 v141, s66, v140
    s_lshl_b32 s84, s5, 18
    s_lshl_b32 s69, s4, 8
    s_add_u32 s84, s84, s69
    v_lshlrev_b32 v13, 2, v13
    v_mov_b32 v240, 0
    v_mov_b32 v241, 0
    v_lshlrev_b32 v242, 3, v1
    ds_write_b64 v242, v[240:241] offset:47616
    ds_write_b64 v242, v[240:241] offset:52224
    buffer_load_dwordx4 v[120:123], v132, s[44:47], 0 offen
    buffer_load_dwordx2 v[124:125], v133, s[44:47], 0 offen
    buffer_load_dwordx4 v[126:129], v134, s[44:47], 0 offen
    buffer_load_dwordx2 v[130:131], v135, s[44:47], 0 offen
    buffer_load_dwordx4 v[176:179], v132, s[48:51], 0 offen
    buffer_load_dwordx2 v[180:181], v133, s[48:51], 0 offen
    buffer_load_dwordx4 v[246:249], v134, s[48:51], 0 offen
    buffer_load_dwordx2 v[250:251], v135, s[48:51], 0 offen
    s_waitcnt vmcnt(20)
    v_perm_b32 v144, v16, v20, s81
    v_perm_b32 v145, v20, v24, s81
    v_perm_b32 v146, v24, v28, s81
    v_perm_b32 v147, v28, v32, s81
    v_perm_b32 v148, v16, v20, s82
    v_perm_b32 v149, v20, v24, s82
    v_perm_b32 v150, v24, v28, s82
    v_perm_b32 v151, v28, v32, s82
    v_perm_b32 v152, v17, v21, s81
    v_perm_b32 v153, v21, v25, s81
    v_perm_b32 v154, v25, v29, s81
    v_perm_b32 v155, v29, v33, s81
    v_perm_b32 v156, v17, v21, s82
    v_perm_b32 v157, v21, v25, s82
    v_perm_b32 v158, v25, v29, s82
    v_perm_b32 v159, v29, v33, s82
    v_perm_b32 v160, v18, v22, s81
    v_perm_b32 v161, v22, v26, s81
    v_perm_b32 v162, v26, v30, s81
    v_perm_b32 v163, v30, v34, s81
    v_perm_b32 v164, v18, v22, s82
    v_perm_b32 v165, v22, v26, s82
    v_perm_b32 v166, v26, v30, s82
    v_perm_b32 v167, v30, v34, s82
    v_perm_b32 v168, v19, v23, s81
    v_perm_b32 v169, v23, v27, s81
    v_perm_b32 v170, v27, v31, s81
    v_perm_b32 v171, v31, v35, s81
    v_perm_b32 v172, v19, v23, s82
    v_perm_b32 v173, v23, v27, s82
    v_perm_b32 v174, v27, v31, s82
    v_perm_b32 v175, v31, v35, s82
    v_dot2_f32_bf16 v184, v144, v45, 0
    v_dot2_f32_bf16 v185, v148, v47, 0
    v_dot2_f32_bf16 v188, v152, v49, 0
    v_dot2_f32_bf16 v189, v156, v51, 0
    v_dot2_f32_bf16 v192, v160, v53, 0
    v_dot2_f32_bf16 v193, v164, v55, 0
    v_dot2_f32_bf16 v196, v168, v57, 0
    v_dot2_f32_bf16 v197, v172, v59, 0
    v_dot2_f32_bf16 v186, v145, v45, 0
    v_dot2_f32_bf16 v187, v149, v47, 0
    v_dot2_f32_bf16 v190, v153, v49, 0
    v_dot2_f32_bf16 v191, v157, v51, 0
    v_dot2_f32_bf16 v194, v161, v53, 0
    v_dot2_f32_bf16 v195, v165, v55, 0
    v_dot2_f32_bf16 v198, v169, v57, 0
    v_dot2_f32_bf16 v199, v173, v59, 0
    v_dot2_f32_bf16 v184, v146, v44, v184
    v_dot2_f32_bf16 v185, v150, v46, v185
    v_dot2_f32_bf16 v188, v154, v48, v188
    v_dot2_f32_bf16 v189, v158, v50, v189
    v_dot2_f32_bf16 v192, v162, v52, v192
    v_dot2_f32_bf16 v193, v166, v54, v193
    v_dot2_f32_bf16 v196, v170, v56, v196
    v_dot2_f32_bf16 v197, v174, v58, v197
    v_dot2_f32_bf16 v186, v147, v44, v186
    v_dot2_f32_bf16 v187, v151, v46, v187
    v_dot2_f32_bf16 v190, v155, v48, v190
    v_dot2_f32_bf16 v191, v159, v50, v191
    v_dot2_f32_bf16 v194, v163, v52, v194
    v_dot2_f32_bf16 v195, v167, v54, v195
    v_dot2_f32_bf16 v198, v171, v56, v198
    v_dot2_f32_bf16 v199, v175, v58, v199
    v_lshlrev_b32 v200, 16, v36
    v_and_b32 v201, s80, v36
    v_lshlrev_b32 v204, 16, v37
    v_and_b32 v205, s80, v37
    v_lshlrev_b32 v208, 16, v38
    v_and_b32 v209, s80, v38
    v_lshlrev_b32 v212, 16, v39
    v_and_b32 v213, s80, v39
    v_lshlrev_b32 v202, 16, v40
    v_and_b32 v203, s80, v40
    v_lshlrev_b32 v206, 16, v41
    v_and_b32 v207, s80, v41
    v_lshlrev_b32 v210, 16, v42
    v_and_b32 v211, s80, v42
    v_lshlrev_b32 v214, 16, v43
    v_and_b32 v215, s80, v43
    v_pk_mul_f32 v[184:185], v[184:185], v[200:201]
    v_pk_mul_f32 v[186:187], v[186:187], v[202:203]
    v_pk_mul_f32 v[188:189], v[188:189], v[204:205]
    v_pk_mul_f32 v[190:191], v[190:191], v[206:207]
    v_pk_mul_f32 v[192:193], v[192:193], v[208:209]
    v_pk_mul_f32 v[194:195], v[194:195], v[210:211]
    v_pk_mul_f32 v[196:197], v[196:197], v[212:213]
    v_pk_mul_f32 v[198:199], v[198:199], v[214:215]
    v_cvt_pk_bf16_f32 v232, v184, v185
    v_cvt_pk_bf16_f32 v233, v186, v187
    v_cvt_pk_bf16_f32 v234, v188, v189
    v_cvt_pk_bf16_f32 v235, v190, v191
    v_cvt_pk_bf16_f32 v236, v192, v193
    v_cvt_pk_bf16_f32 v237, v194, v195
    v_cvt_pk_bf16_f32 v238, v196, v197
    v_cvt_pk_bf16_f32 v239, v198, v199
    ds_write_b64 v136, v[232:233] offset:0
    ds_write_b64 v136, v[234:235] offset:272
    ds_write_b64 v136, v[236:237] offset:544
    ds_write_b64 v136, v[238:239] offset:816
    v_add_u32 v15, 8704, v136
    s_waitcnt vmcnt(18)
    ds_write2_b32 v15, v60, v64 offset0:0 offset1:1
    ds_write2_b32 v15, v61, v65 offset0:68 offset1:69
    ds_write2_b32 v15, v62, v66 offset0:136 offset1:137
    ds_write2_b32 v15, v63, v67 offset0:204 offset1:205
    s_waitcnt vmcnt(14)
    s_mov_b32 s71, 0x3f803f80
    v_dot2_f32_bf16 v240, v68, s71, 0
    v_dot2_f32_bf16 v244, v68, v68, 0
    v_dot2_f32_bf16 v241, v69, s71, 0
    v_dot2_f32_bf16 v245, v69, v69, 0
    v_dot2_f32_bf16 v240, v70, s71, v240
    v_dot2_f32_bf16 v244, v70, v70, v244
    v_dot2_f32_bf16 v241, v71, s71, v241
    v_dot2_f32_bf16 v245, v71, v71, v245
    v_dot2_f32_bf16 v240, v72, s71, v240
    v_dot2_f32_bf16 v244, v72, v72, v244
    v_dot2_f32_bf16 v241, v73, s71, v241
    v_dot2_f32_bf16 v245, v73, v73, v245
    v_dot2_f32_bf16 v240, v74, s71, v240
    v_dot2_f32_bf16 v244, v74, v74, v244
    v_dot2_f32_bf16 v241, v75, s71, v241
    v_dot2_f32_bf16 v245, v75, v75, v245
    v_dot2_f32_bf16 v240, v76, s71, v240
    v_dot2_f32_bf16 v244, v76, v76, v244
    v_dot2_f32_bf16 v241, v77, s71, v241
    v_dot2_f32_bf16 v245, v77, v77, v245
    v_dot2_f32_bf16 v240, v78, s71, v240
    v_dot2_f32_bf16 v244, v78, v78, v244
    v_dot2_f32_bf16 v241, v79, s71, v241
    v_dot2_f32_bf16 v245, v79, v79, v245
    v_dot2_f32_bf16 v240, v80, s71, v240
    v_dot2_f32_bf16 v244, v80, v80, v244
    v_dot2_f32_bf16 v241, v81, s71, v241
    v_dot2_f32_bf16 v245, v81, v81, v245
    v_dot2_f32_bf16 v240, v82, s71, v240
    v_dot2_f32_bf16 v244, v82, v82, v244
    v_dot2_f32_bf16 v241, v83, s71, v241
    v_dot2_f32_bf16 v245, v83, v83, v245
    s_nop 1
    v_add_f32 v240, v240, v241
    v_add_f32 v244, v244, v245
    s_nop 0
    v_add_f32_dpp v240, v240, v240 quad_perm:[1,0,3,2] row_mask:0xf bank_mask:0xf
    v_add_f32_dpp v244, v244, v244 quad_perm:[1,0,3,2] row_mask:0xf bank_mask:0xf
    s_nop 0
    v_add_f32_dpp v240, v240, v240 quad_perm:[2,3,0,1] row_mask:0xf bank_mask:0xf
    v_add_f32_dpp v244, v244, v244 quad_perm:[2,3,0,1] row_mask:0xf bank_mask:0xf
    s_nop 0
    v_add_f32_dpp v240, v240, v240 row_half_mirror row_mask:0xf bank_mask:0xf
    v_add_f32_dpp v244, v244, v244 row_half_mirror row_mask:0xf bank_mask:0xf
    s_nop 0
    v_add_f32_dpp v240, v240, v240 row_mirror row_mask:0xf bank_mask:0xf
    v_add_f32_dpp v244, v244, v244 row_mirror row_mask:0xf bank_mask:0xf
    s_mov_b32 s69, 0x3b124925
    s_mov_b32 s70, 0x3727c5ac
    v_mul_f32 v240, s69, v240
    v_mul_f32 v244, s69, v244
    v_fma_f32 v244, -v240, v240, v244
    v_max_f32 v244, 0, v244
    v_add_f32 v244, s70, v244
    v_rsq_f32 v244, v244
    s_waitcnt lgkmcnt(0)
    s_barrier
    ds_read_b128 v[16:19], v138 offset:0
    ds_read_b128 v[20:23], v138 offset:4352
    ds_read_b128 v[24:27], v138 offset:8704
    ds_read_b128 v[28:31], v138 offset:13056
    v_mul_f32 v240, v240, v244
    s_add_u32 s69, s84, 262144
    s_add_u32 s70, s84, 393216
    s_add_u32 s71, s84, 2097152
    s_add_u32 s73, s84, 2228224
    s_waitcnt lgkmcnt(2)
    buffer_store_dwordx4 v[16:19], v139, s[36:39], s69 offen sc1
    buffer_store_dwordx4 v[20:23], v139, s[36:39], s70 offen sc1
    s_waitcnt lgkmcnt(0)
    buffer_store_dwordx4 v[24:27], v139, s[36:39], s71 offen sc1
    buffer_store_dwordx4 v[28:31], v139, s[36:39], s73 offen sc1
    s_mov_b32 s69, 3932160
    s_mov_b32 s70, 3940352
    s_mov_b32 exec_lo, 0x00010001
    s_mov_b32 exec_hi, 0x00010001
    buffer_store_dword v244, v13, s[36:39], s69 offen sc1
    buffer_store_dword v240, v13, s[36:39], s70 offen sc1
    s_mov_b64 exec, -1
    buffer_load_dwordx4 v[216:219], v14, s[52:55], 0 offen
    v_add_u32 v14, s64, v14
    buffer_load_dwordx4 v[220:223], v14, s[52:55], 0 offen
    v_add_u32 v14, s64, v14
    buffer_load_dwordx4 v[224:227], v14, s[52:55], 0 offen
    v_add_u32 v14, s64, v14
    buffer_load_dwordx4 v[228:231], v14, s[52:55], 0 offen
    s_mov_b32 s70, 0xbfb8aa3b
    s_waitcnt vmcnt(21)
    v_lshlrev_b32 v96, 16, v96
    v_lshlrev_b32 v97, 16, v97
    v_lshlrev_b32 v98, 16, v98
    v_mul_f32 v108, s70, v96
    v_mul_f32 v109, s70, v97
    v_mul_f32 v110, s70, v98
    v_exp_f32 v108, v108
    v_exp_f32 v109, v109
    v_exp_f32 v110, v110
    v_add_f32 v108, 1.0, v108
    v_add_f32 v109, 1.0, v109
    v_add_f32 v110, 1.0, v110
    v_rcp_f32 v108, v108
    v_rcp_f32 v109, v109
    v_rcp_f32 v110, v110
    s_lshl_b32 s71, s6, 2
    v_lshrrev_b32 v117, 4, v1
    v_add_u32 v117, s71, v117
    v_mul_f32 v96, v96, v108
    v_mul_f32 v97, v97, v109
    v_mul_f32 v98, v98, v110
    v_mul_u32_u24 v117, 272, v117
    v_and_b32 v116, 7, v1
    v_cvt_pk_bf16_f32 v96, v96, v96
    v_cvt_pk_bf16_f32 v97, v97, v97
    v_cvt_pk_bf16_f32 v98, v98, v98
    v_lshl_add_u32 v117, v116, 5, v117
    v_and_b32 v96, s80, v96
    v_and_b32 v97, s80, v97
    v_and_b32 v98, s80, v98
    v_add_u32 v117, 17408, v117
    s_waitcnt vmcnt(18)
    v_lshlrev_b32 v108, 16, v84
    v_and_b32 v109, s80, v84
    v_lshlrev_b32 v110, 16, v85
    v_and_b32 v111, s80, v85
    v_lshlrev_b32 v112, 16, v86
    v_and_b32 v113, s80, v86
    v_lshlrev_b32 v114, 16, v87
    v_and_b32 v115, s80, v87
    v_pk_mul_f32 v[100:101], v[108:109], v[96:97] op_sel:[0,0] op_sel_hi:[1,0]
    v_pk_mul_f32 v[102:103], v[110:111], v[96:97] op_sel:[0,0] op_sel_hi:[1,0]
    v_pk_mul_f32 v[104:105], v[112:113], v[96:97] op_sel:[0,0] op_sel_hi:[1,0]
    v_pk_mul_f32 v[106:107], v[114:115], v[96:97] op_sel:[0,0] op_sel_hi:[1,0]
    v_lshlrev_b32 v108, 16, v88
    v_and_b32 v109, s80, v88
    v_lshlrev_b32 v110, 16, v89
    v_and_b32 v111, s80, v89
    v_lshlrev_b32 v112, 16, v90
    v_and_b32 v113, s80, v90
    v_lshlrev_b32 v114, 16, v91
    v_and_b32 v115, s80, v91
    v_pk_fma_f32 v[100:101], v[108:109], v[96:97], v[100:101] op_sel:[0,1,0] op_sel_hi:[1,1,1]
    v_pk_fma_f32 v[102:103], v[110:111], v[96:97], v[102:103] op_sel:[0,1,0] op_sel_hi:[1,1,1]
    v_pk_fma_f32 v[104:105], v[112:113], v[96:97], v[104:105] op_sel:[0,1,0] op_sel_hi:[1,1,1]
    v_pk_fma_f32 v[106:107], v[114:115], v[96:97], v[106:107] op_sel:[0,1,0] op_sel_hi:[1,1,1]
    v_lshlrev_b32 v108, 16, v92
    v_and_b32 v109, s80, v92
    v_lshlrev_b32 v110, 16, v93
    v_and_b32 v111, s80, v93
    v_lshlrev_b32 v112, 16, v94
    v_and_b32 v113, s80, v94
    v_lshlrev_b32 v114, 16, v95
    v_and_b32 v115, s80, v95
    v_pk_fma_f32 v[100:101], v[108:109], v[98:99], v[100:101] op_sel:[0,0,0] op_sel_hi:[1,0,1]
    v_pk_fma_f32 v[102:103], v[110:111], v[98:99], v[102:103] op_sel:[0,0,0] op_sel_hi:[1,0,1]
    v_pk_fma_f32 v[104:105], v[112:113], v[98:99], v[104:105] op_sel:[0,0,0] op_sel_hi:[1,0,1]
    v_pk_fma_f32 v[106:107], v[114:115], v[98:99], v[106:107] op_sel:[0,0,0] op_sel_hi:[1,0,1]
    v_add_f32_dpp v100, v100, v100 row_ror:8 row_mask:0xf bank_mask:0xf
    v_add_f32_dpp v101, v101, v101 row_ror:8 row_mask:0xf bank_mask:0xf
    v_add_f32_dpp v102, v102, v102 row_ror:8 row_mask:0xf bank_mask:0xf
    v_add_f32_dpp v103, v103, v103 row_ror:8 row_mask:0xf bank_mask:0xf
    v_add_f32_dpp v104, v104, v104 row_ror:8 row_mask:0xf bank_mask:0xf
    v_add_f32_dpp v105, v105, v105 row_ror:8 row_mask:0xf bank_mask:0xf
    v_add_f32_dpp v106, v106, v106 row_ror:8 row_mask:0xf bank_mask:0xf
    v_add_f32_dpp v107, v107, v107 row_ror:8 row_mask:0xf bank_mask:0xf
    ds_write_b128 v117, v[100:103]
    ds_write_b128 v117, v[104:107] offset:16
    s_waitcnt vmcnt(16)
    v_alignbit_b32 v48, v121, v120, 16
    v_alignbit_b32 v49, v122, v121, 16
    v_alignbit_b32 v50, v123, v122, 16
    v_alignbit_b32 v51, v124, v123, 16
    v_mov_b32 v52, v121
    v_mov_b32 v53, v122
    v_mov_b32 v54, v123
    v_mov_b32 v55, v124
    v_alignbit_b32 v56, v122, v121, 16
    v_alignbit_b32 v57, v123, v122, 16
    v_alignbit_b32 v58, v124, v123, 16
    v_alignbit_b32 v59, v125, v124, 16
    ds_write_b128 v142, v[120:123] offset:0
    ds_write_b128 v142, v[48:51] offset:4160
    ds_write_b128 v142, v[52:55] offset:8320
    ds_write_b128 v142, v[56:59] offset:12480
    s_waitcnt vmcnt(14)
    v_alignbit_b32 v48, v127, v126, 16
    v_alignbit_b32 v49, v128, v127, 16
    v_alignbit_b32 v50, v129, v128, 16
    v_alignbit_b32 v51, v130, v129, 16
    v_mov_b32 v52, v127
    v_mov_b32 v53, v128
    v_mov_b32 v54, v129
    v_mov_b32 v55, v130
    v_alignbit_b32 v56, v128, v127, 16
    v_alignbit_b32 v57, v129, v128, 16
    v_alignbit_b32 v58, v130, v129, 16
    v_alignbit_b32 v59, v131, v130, 16
    ds_write_b128 v143, v[126:129] offset:0
    ds_write_b128 v143, v[48:51] offset:4160
    ds_write_b128 v143, v[52:55] offset:8320
    ds_write_b128 v143, v[56:59] offset:12480
    s_waitcnt vmcnt(12)
    v_alignbit_b32 v48, v177, v176, 16
    v_alignbit_b32 v49, v178, v177, 16
    v_alignbit_b32 v50, v179, v178, 16
    v_alignbit_b32 v51, v180, v179, 16
    v_mov_b32 v52, v177
    v_mov_b32 v53, v178
    v_mov_b32 v54, v179
    v_mov_b32 v55, v180
    v_alignbit_b32 v56, v178, v177, 16
    v_alignbit_b32 v57, v179, v178, 16
    v_alignbit_b32 v58, v180, v179, 16
    v_alignbit_b32 v59, v181, v180, 16
    ds_write_b128 v142, v[176:179] offset:16640
    ds_write_b128 v142, v[48:51] offset:20800
    ds_write_b128 v142, v[52:55] offset:24960
    ds_write_b128 v142, v[56:59] offset:29120
    s_waitcnt vmcnt(10)
    v_alignbit_b32 v48, v247, v246, 16
    v_alignbit_b32 v49, v248, v247, 16
    v_alignbit_b32 v50, v249, v248, 16
    v_alignbit_b32 v51, v250, v249, 16
    v_mov_b32 v52, v247
    v_mov_b32 v53, v248
    v_mov_b32 v54, v249
    v_mov_b32 v55, v250
    v_alignbit_b32 v56, v248, v247, 16
    v_alignbit_b32 v57, v249, v248, 16
    v_alignbit_b32 v58, v250, v249, 16
    v_alignbit_b32 v59, v251, v250, 16
    ds_write_b128 v143, v[246:249] offset:16640
    ds_write_b128 v143, v[48:51] offset:20800
    ds_write_b128 v143, v[52:55] offset:24960
    ds_write_b128 v143, v[56:59] offset:29120
    s_add_u32 s56, s56, 1
    s_lshl_b32 s69, s7, 7
    s_add_u32 s69, s69, 4096
    s_waitcnt vmcnt(4)
    s_waitcnt lgkmcnt(0)
    s_barrier
    s_cmp_lg_u32 s6, 0
    s_cbranch_scc1 L_fl_1
    v_mov_b32 v252, s56
    v_mov_b32 v254, s69
    s_mov_b64 exec, 1
    buffer_store_dword v252, v254, s[36:39], 0 offen sc1
    s_mov_b64 exec, -1
L_fl_1:
    s_waitcnt vmcnt(0)
    ds_write_b128 v137, v[216:219] offset:26112
    ds_write_b128 v137, v[220:223] offset:27200
    ds_write_b128 v137, v[224:227] offset:28288
    ds_write_b128 v137, v[228:231] offset:29376
    s_waitcnt lgkmcnt(0)
    s_barrier
    ds_read_b64_tr_b16 v[220:221], v140 offset:26112
    ds_read_b64_tr_b16 v[222:223], v141 offset:26112
    ds_read_b64_tr_b16 v[224:225], v140 offset:26368
    ds_read_b64_tr_b16 v[226:227], v141 offset:26368
    ds_read_b64_tr_b16 v[228:229], v140 offset:26624
    ds_read_b64_tr_b16 v[230:231], v141 offset:26624
    ds_read_b64_tr_b16 v[232:233], v140 offset:26880
    ds_read_b64_tr_b16 v[234:235], v141 offset:26880
    v_lshlrev_b32 v118, 2, v1
    v_add_u32 v119, 17408, v118
    ds_read_b32 v100, v119 offset:0
    ds_read_b32 v101, v119 offset:272
    ds_read_b32 v102, v119 offset:544
    ds_read_b32 v103, v119 offset:816
    ds_read_b32 v104, v119 offset:1088
    ds_read_b32 v105, v119 offset:1360
    ds_read_b32 v106, v119 offset:1632
    ds_read_b32 v107, v119 offset:1904
    ds_read_b32 v108, v119 offset:2176
    ds_read_b32 v109, v119 offset:2448
    ds_read_b32 v110, v119 offset:2720
    ds_read_b32 v111, v119 offset:2992
    ds_read_b32 v112, v119 offset:3264
    ds_read_b32 v113, v119 offset:3536
    ds_read_b32 v114, v119 offset:3808
    ds_read_b32 v115, v119 offset:4080
    s_mul_i32 s62, s62, 10752
    s_lshl_b32 s78, s78, 8
    s_add_u32 s62, s62, s78
    s_add_u32 s62, s62, 8994816
    s_waitcnt lgkmcnt(0)
    v_add_f32 v100, v100, v108
    v_add_f32 v101, v101, v109
    v_add_f32 v102, v102, v110
    v_add_f32 v103, v103, v111
    v_add_f32 v104, v104, v112
    v_add_f32 v105, v105, v113
    v_add_f32 v106, v106, v114
    v_add_f32 v107, v107, v115
    v_add_f32 v100, v100, v104
    v_add_f32 v101, v101, v105
    v_add_f32 v102, v102, v106
    v_add_f32 v103, v103, v107
    v_add_f32 v100, v100, v102
    v_add_f32 v101, v101, v103
    v_add_f32 v100, v100, v101
    buffer_store_dwordx4 v[220:223], v4, s[36:39], s67 offen sc1
    s_add_u32 s67, s67, s68
    buffer_store_dwordx4 v[224:227], v4, s[36:39], s67 offen sc1
    s_add_u32 s67, s67, s68
    buffer_store_dwordx4 v[228:231], v4, s[36:39], s67 offen sc1
    s_add_u32 s67, s67, s68
    s_cmp_ge_u32 s6, 2
    s_cbranch_scc1 L_w4_2
    buffer_store_dwordx4 v[232:235], v4, s[36:39], s67 offen sc1
L_w4_2:
    v_mov_b32 v236, -1
    v_mov_b32 v237, -1
    v_mov_b32 v238, -1
    v_mov_b32 v239, -1
    s_lshl_b32 s69, s93, 13
    s_lshl_b32 s70, s6, 11
    s_add_u32 s69, s69, s70
    s_add_u32 s69, s69, 3948544
    buffer_store_dwordx4 v[236:239], v4, s[36:39], s69 offen offset:0 sc1
    buffer_store_dwordx4 v[236:239], v4, s[36:39], s69 offen offset:1024 sc1
    s_cmp_lg_u32 s6, 0
    s_cbranch_scc1 L_ms_3
    buffer_store_dword v100, v118, s[36:39], s62 offen sc1
L_ms_3:
    v_min_u32 v2, 55, v1
    s_mul_i32 s57, s6, 56
    v_add_u32 v2, s57, v2
    v_lshlrev_b32 v2, 7, v2
    v_add_u32 v2, 4096, v2
    s_lshl_b32 s86, s7, 13
    s_lshl_b32 s59, s6, 11
    s_add_u32 s86, s86, s59
    s_lshl_b32 s57, s6, 10
    s_sub_u32 s57, 3576, s57
    v_lshlrev_b32 v16, 3, v1
    v_sub_u32 v5, s57, v16
    v_and_b32 v16, 15, v1
    v_add_u32 v16, 1, v16
    v_and_b32 v17, 3, v16
    v_sub_u32 v16, v16, v17
    v_lshlrev_b32 v16, 1, v16
    v_mul_u32_u24 v17, 4160, v17
    v_add_u32 v6, v16, v17
    v_lshrrev_b32 v17, 4, v1
    v_lshl_add_u32 v6, v17, 4, v6
    s_lshr_b32 s57, s6, 1
    s_and_b32 s58, s6, 1
    s_mul_i32 s59, s57, 16640
    s_lshl_b32 s58, s58, 8
    s_add_u32 s59, s59, s58
    s_add_u32 s59, s59, 57344
    v_add_u32 v6, s59, v6
    v_and_b32 v16, 15, v1
    v_lshlrev_b32 v16, 5, v16
    v_lshlrev_b32 v17, 4, v17
    v_sub_u32 v7, v17, v16
    s_mul_i32 s59, s57, 4608
    s_add_u32 s59, s59, s58
    s_add_u32 s59, s59, 44000
    v_add_u32 v7, s59, v7
    v_add_u32 v18, 32768, v2
    s_add_u32 s58, s86, 262144
    s_mov_b32 s96, 0
L_poll_4:
    buffer_load_dword v3, v2, s[36:39], 0 offen sc1
    s_waitcnt vmcnt(0)
    v_cmp_ne_u32 vcc, s56, v3
    s_add_u32 s96, s96, 1
    s_nop 3
    s_cmp_eq_u64 vcc, 0
    s_cbranch_scc1 L_polld_5
    s_mov_b64 exec, vcc
    s_cmp_lt_u32 s96, 131072
    s_cbranch_scc1 L_poll_4
L_polld_5:
    s_mov_b64 exec, -1
    s_barrier
    s_lshl_b32 s57, s61, 7
    s_add_u32 s57, s57, 36864
    s_cmp_lg_u32 s6, 0
    s_cbranch_scc1 L_fl_6
    v_mov_b32 v252, s56
    v_mov_b32 v254, s57
    s_mov_b64 exec, 1
    buffer_store_dword v252, v254, s[36:39], 0 offen sc1
    s_mov_b64 exec, -1
L_fl_6:
    s_cmp_lg_u32 s7, 0
    s_cbranch_scc1 L_ep_7
    s_mov_b32 s57, 0
    s_cmp_lg_u32 s6, 0
    s_cbranch_scc1 L_fl_8
    v_mov_b32 v252, s56
    v_mov_b32 v254, s57
    s_mov_b64 exec, 1
    buffer_store_dword v252, v254, s[36:39], 0 offen sc1
    s_mov_b64 exec, -1
L_fl_8:
L_ep_7:
    buffer_load_dwordx4 v[8:11], v4, s[36:39], s58 offen offset:0 sc1
    buffer_load_dwordx4 v[12:15], v4, s[36:39], s58 offen offset:1024 sc1
    s_add_u32 s73, s86, 2097152
    buffer_load_dwordx4 v[144:147], v4, s[36:39], s73 offen offset:0 sc1
    buffer_load_dwordx4 v[148:151], v4, s[36:39], s73 offen offset:1024 sc1
    s_lshl_b32 s72, s6, 11
    s_add_u32 s73, s72, 3932160
    s_add_u32 s74, s72, 3940352
    buffer_load_dwordx4 v[152:155], v4, s[36:39], s73 offen offset:0 sc1
    buffer_load_dwordx4 v[160:163], v4, s[36:39], s74 offen offset:0 sc1
    buffer_load_dwordx4 v[156:159], v4, s[36:39], s73 offen offset:1024 sc1
    buffer_load_dwordx4 v[164:167], v4, s[36:39], s74 offen offset:1024 sc1
    s_mov_b32 s40, s18
    s_mov_b32 s41, s19
    s_mov_b32 s42, 896
    s_mov_b32 s43, 0x00020000
    s_lshl_b32 s72, s7, 2
    v_mov_b32 v185, s72
    buffer_load_dword v175, v185, s[40:43], 0 offen
    s_waitcnt vmcnt(7)
    v_perm_b32 v22, v10, v11, s81
    v_perm_b32 v23, v8, v9, s81
    v_perm_b32 v24, v10, v11, s82
    v_perm_b32 v25, v8, v9, s82
    v_perm_b32 v26, v14, v15, s81
    v_perm_b32 v27, v12, v13, s81
    v_perm_b32 v28, v14, v15, s82
    v_perm_b32 v29, v12, v13, s82
    ds_write_b64 v5, v[22:23] offset:44032
    ds_write_b64 v5, v[24:25] offset:48640
    ds_write_b64 v5, v[26:27] offset:43520
    ds_write_b64 v5, v[28:29] offset:48128
    s_waitcnt lgkmcnt(0)
    s_barrier
    ds_read_b64 v[128:129], v6 offset:0
    ds_read_b64 v[130:131], v6 offset:8
    ds_read_b128 v[64:67], v7 offset:3584
    ds_read_b128 v[68:71], v7 offset:3072
    ds_read_b128 v[72:75], v7 offset:2560
    ds_read_b128 v[76:79], v7 offset:2048
    ds_read_b128 v[80:83], v7 offset:1536
    ds_read_b128 v[84:87], v7 offset:1024
    ds_read_b128 v[88:91], v7 offset:512
    ds_read_b128 v[92:95], v7 offset:0
    ds_read_b64 v[132:133], v6 offset:512
    ds_read_b64 v[134:135], v6 offset:520
    ds_read_b64 v[136:137], v6 offset:1024
    ds_read_b64 v[138:139], v6 offset:1032
    s_lshl_b32 s57, s5, 3
    s_lshl_b32 s58, s6, 1
    s_add_u32 s57, s57, s58
    s_mul_i32 s78, s57, 28672
    s_add_u32 s78, s78, 5783552
    s_lshl_b32 s57, s5, 2
    s_add_u32 s57, s57, s6
    s_mul_i32 s79, s57, 57344
    s_add_u32 s79, s79, 7389184
    v_lshlrev_b32 v3, 4, v1
    s_waitcnt lgkmcnt(4)
    v_mfma_f32_16x16x32_bf16 v[32:35], v[128:131], v[64:67], 0
    ds_read_b64 v[140:141], v6 offset:1536
    ds_read_b64 v[142:143], v6 offset:1544
    ds_read_b128 v[96:99], v7 offset:3648
    ds_read_b128 v[100:103], v7 offset:3136
    v_mfma_f32_16x16x32_bf16 v[36:39], v[128:131], v[68:71], 0
    v_mfma_f32_16x16x32_bf16 v[40:43], v[128:131], v[72:75], 0
    v_mfma_f32_16x16x32_bf16 v[44:47], v[128:131], v[76:79], 0
    v_mfma_f32_16x16x32_bf16 v[48:51], v[128:131], v[80:83], 0
    v_mfma_f32_16x16x32_bf16 v[52:55], v[128:131], v[84:87], 0
    v_mfma_f32_16x16x32_bf16 v[56:59], v[128:131], v[88:91], 0
    v_mfma_f32_16x16x32_bf16 v[60:63], v[128:131], v[92:95], 0
    s_waitcnt lgkmcnt(6)
    v_mfma_f32_16x16x32_bf16 v[36:39], v[132:135], v[64:67], v[36:39]
    ds_read_b64 v[128:129], v6 offset:2048
    ds_read_b64 v[130:131], v6 offset:2056
    ds_read_b128 v[104:107], v7 offset:2624
    ds_read_b128 v[108:111], v7 offset:2112
    v_mfma_f32_16x16x32_bf16 v[40:43], v[132:135], v[68:71], v[40:43]
    v_mfma_f32_16x16x32_bf16 v[44:47], v[132:135], v[72:75], v[44:47]
    v_mfma_f32_16x16x32_bf16 v[48:51], v[132:135], v[76:79], v[48:51]
    v_mfma_f32_16x16x32_bf16 v[52:55], v[132:135], v[80:83], v[52:55]
    v_mfma_f32_16x16x32_bf16 v[56:59], v[132:135], v[84:87], v[56:59]
    v_mfma_f32_16x16x32_bf16 v[60:63], v[132:135], v[88:91], v[60:63]
    s_waitcnt lgkmcnt(8)
    v_mfma_f32_16x16x32_bf16 v[40:43], v[136:139], v[64:67], v[40:43]
    ds_read_b64 v[132:133], v6 offset:2560
    ds_read_b64 v[134:135], v6 offset:2568
    ds_read_b128 v[112:115], v7 offset:1600
    ds_read_b128 v[116:119], v7 offset:1088
    v_mfma_f32_16x16x32_bf16 v[44:47], v[136:139], v[68:71], v[44:47]
    v_mfma_f32_16x16x32_bf16 v[48:51], v[136:139], v[72:75], v[48:51]
    v_mfma_f32_16x16x32_bf16 v[52:55], v[136:139], v[76:79], v[52:55]
    v_mfma_f32_16x16x32_bf16 v[56:59], v[136:139], v[80:83], v[56:59]
    v_mfma_f32_16x16x32_bf16 v[60:63], v[136:139], v[84:87], v[60:63]
    s_waitcnt lgkmcnt(10)
    v_mfma_f32_16x16x32_bf16 v[44:47], v[140:143], v[64:67], v[44:47]
    ds_read_b64 v[136:137], v6 offset:3072
    ds_read_b64 v[138:139], v6 offset:3080
    ds_read_b128 v[120:123], v7 offset:576
    ds_read_b128 v[124:127], v7 offset:64
    v_mfma_f32_16x16x32_bf16 v[48:51], v[140:143], v[68:71], v[48:51]
    v_mfma_f32_16x16x32_bf16 v[52:55], v[140:143], v[72:75], v[52:55]
    v_mfma_f32_16x16x32_bf16 v[56:59], v[140:143], v[76:79], v[56:59]
    v_mfma_f32_16x16x32_bf16 v[60:63], v[140:143], v[80:83], v[60:63]
    s_waitcnt lgkmcnt(10)
    v_mfma_f32_16x16x32_bf16 v[48:51], v[128:131], v[64:67], v[48:51]
    ds_read_b64 v[140:141], v6 offset:3584
    ds_read_b64 v[142:143], v6 offset:3592
    v_mfma_f32_16x16x32_bf16 v[52:55], v[128:131], v[68:71], v[52:55]
    v_mfma_f32_16x16x32_bf16 v[56:59], v[128:131], v[72:75], v[56:59]
    v_mfma_f32_16x16x32_bf16 v[60:63], v[128:131], v[76:79], v[60:63]
    s_waitcnt lgkmcnt(8)
    v_mfma_f32_16x16x32_bf16 v[52:55], v[132:135], v[64:67], v[52:55]
    ds_read_b64 v[128:129], v6 offset:64
    ds_read_b64 v[130:131], v6 offset:72
    v_mfma_f32_16x16x32_bf16 v[56:59], v[132:135], v[68:71], v[56:59]
    v_mfma_f32_16x16x32_bf16 v[60:63], v[132:135], v[72:75], v[60:63]
    s_waitcnt lgkmcnt(6)
    v_mfma_f32_16x16x32_bf16 v[56:59], v[136:139], v[64:67], v[56:59]
    ds_read_b64 v[132:133], v6 offset:576
    ds_read_b64 v[134:135], v6 offset:584
    v_mfma_f32_16x16x32_bf16 v[60:63], v[136:139], v[68:71], v[60:63]
    s_waitcnt lgkmcnt(4)
    v_mfma_f32_16x16x32_bf16 v[60:63], v[140:143], v[64:67], v[60:63]
    ds_read_b64 v[136:137], v6 offset:1088
    ds_read_b64 v[138:139], v6 offset:1096
    v_lshrrev_b32 v16, 3, v1
    v_min_u32 v16, 2, v16
    v_mul_u32_u24 v16, 448, v16
    s_lshl_b32 s57, s7, 1
    v_add_u32 v16, s57, v16
    v_lshrrev_b32 v16, 6, v16
    v_and_b32 v17, 7, v1
    v_min_u32 v17, 4, v17
    v_mad_u32_u24 v213, v17, 42, v16
    v_lshlrev_b32 v213, 7, v213
    v_add_u32 v213, 36864, v213
    buffer_load_dword v214, v213, s[36:39], 0 offen sc1
    s_waitcnt lgkmcnt(4)
    v_mfma_f32_16x16x32_bf16 v[32:35], v[128:131], v[96:99], v[32:35]
    ds_read_b64 v[140:141], v6 offset:1600
    ds_read_b64 v[142:143], v6 offset:1608
    ds_read_b128 v[64:67], v7 offset:3712
    ds_read_b128 v[68:71], v7 offset:3200
    v_mfma_f32_16x16x32_bf16 v[36:39], v[128:131], v[100:103], v[36:39]
    v_mfma_f32_16x16x32_bf16 v[40:43], v[128:131], v[104:107], v[40:43]
    v_mfma_f32_16x16x32_bf16 v[44:47], v[128:131], v[108:111], v[44:47]
    v_mfma_f32_16x16x32_bf16 v[48:51], v[128:131], v[112:115], v[48:51]
    v_mfma_f32_16x16x32_bf16 v[52:55], v[128:131], v[116:119], v[52:55]
    v_mfma_f32_16x16x32_bf16 v[56:59], v[128:131], v[120:123], v[56:59]
    v_mfma_f32_16x16x32_bf16 v[60:63], v[128:131], v[124:127], v[60:63]
    s_waitcnt lgkmcnt(6)
    v_mfma_f32_16x16x32_bf16 v[36:39], v[132:135], v[96:99], v[36:39]
    ds_read_b64 v[128:129], v6 offset:2112
    ds_read_b64 v[130:131], v6 offset:2120
    ds_read_b128 v[72:75], v7 offset:2688
    ds_read_b128 v[76:79], v7 offset:2176
    v_mfma_f32_16x16x32_bf16 v[40:43], v[132:135], v[100:103], v[40:43]
    v_mfma_f32_16x16x32_bf16 v[44:47], v[132:135], v[104:107], v[44:47]
    v_mfma_f32_16x16x32_bf16 v[48:51], v[132:135], v[108:111], v[48:51]
    v_mfma_f32_16x16x32_bf16 v[52:55], v[132:135], v[112:115], v[52:55]
    v_mfma_f32_16x16x32_bf16 v[56:59], v[132:135], v[116:119], v[56:59]
    v_mfma_f32_16x16x32_bf16 v[60:63], v[132:135], v[120:123], v[60:63]
    s_waitcnt lgkmcnt(8)
    v_mfma_f32_16x16x32_bf16 v[40:43], v[136:139], v[96:99], v[40:43]
    ds_read_b64 v[132:133], v6 offset:2624
    ds_read_b64 v[134:135], v6 offset:2632
    ds_read_b128 v[80:83], v7 offset:1664
    ds_read_b128 v[84:87], v7 offset:1152
    v_mfma_f32_16x16x32_bf16 v[44:47], v[136:139], v[100:103], v[44:47]
    v_mfma_f32_16x16x32_bf16 v[48:51], v[136:139], v[104:107], v[48:51]
    v_mfma_f32_16x16x32_bf16 v[52:55], v[136:139], v[108:111], v[52:55]
    v_mfma_f32_16x16x32_bf16 v[56:59], v[136:139], v[112:115], v[56:59]
    v_mfma_f32_16x16x32_bf16 v[60:63], v[136:139], v[116:119], v[60:63]
    s_waitcnt lgkmcnt(10)
    v_mfma_f32_16x16x32_bf16 v[44:47], v[140:143], v[96:99], v[44:47]
    ds_read_b64 v[136:137], v6 offset:3136
    ds_read_b64 v[138:139], v6 offset:3144
    ds_read_b128 v[88:91], v7 offset:640
    ds_read_b128 v[92:95], v7 offset:128
    v_mfma_f32_16x16x32_bf16 v[48:51], v[140:143], v[100:103], v[48:51]
    v_mfma_f32_16x16x32_bf16 v[52:55], v[140:143], v[104:107], v[52:55]
    v_mfma_f32_16x16x32_bf16 v[56:59], v[140:143], v[108:111], v[56:59]
    v_mfma_f32_16x16x32_bf16 v[60:63], v[140:143], v[112:115], v[60:63]
    s_waitcnt lgkmcnt(10)
    v_mfma_f32_16x16x32_bf16 v[48:51], v[128:131], v[96:99], v[48:51]
    ds_read_b64 v[140:141], v6 offset:3648
    ds_read_b64 v[142:143], v6 offset:3656
    v_mfma_f32_16x16x32_bf16 v[52:55], v[128:131], v[100:103], v[52:55]
    v_mfma_f32_16x16x32_bf16 v[56:59], v[128:131], v[104:107], v[56:59]
    v_mfma_f32_16x16x32_bf16 v[60:63], v[128:131], v[108:111], v[60:63]
    s_waitcnt lgkmcnt(8)
    v_mfma_f32_16x16x32_bf16 v[52:55], v[132:135], v[96:99], v[52:55]
    ds_read_b64 v[128:129], v6 offset:128
    ds_read_b64 v[130:131], v6 offset:136
    v_mfma_f32_16x16x32_bf16 v[56:59], v[132:135], v[100:103], v[56:59]
    v_mfma_f32_16x16x32_bf16 v[60:63], v[132:135], v[104:107], v[60:63]
    s_waitcnt lgkmcnt(6)
    v_mfma_f32_16x16x32_bf16 v[56:59], v[136:139], v[96:99], v[56:59]
    ds_read_b64 v[132:133], v6 offset:640
    ds_read_b64 v[134:135], v6 offset:648
    v_mfma_f32_16x16x32_bf16 v[60:63], v[136:139], v[100:103], v[60:63]
    s_waitcnt lgkmcnt(4)
    v_mfma_f32_16x16x32_bf16 v[60:63], v[140:143], v[96:99], v[60:63]
    ds_read_b64 v[136:137], v6 offset:1152
    ds_read_b64 v[138:139], v6 offset:1160
    s_waitcnt vmcnt(0)
    v_cmp_ne_u32 vcc, s56, v214
    s_nop 1
    s_cmp_eq_u64 vcc, 0
    s_cbranch_scc1 L_p1d_9
    s_mov_b32 s96, 0
L_poll_10:
    buffer_load_dword v214, v213, s[36:39], 0 offen sc1
    s_waitcnt vmcnt(0)
    v_cmp_ne_u32 vcc, s56, v214
    s_add_u32 s96, s96, 1
    s_nop 3
    s_cmp_eq_u64 vcc, 0
    s_cbranch_scc1 L_polld_11
    s_mov_b64 exec, vcc
    s_cmp_lt_u32 s96, 131072
    s_cbranch_scc1 L_poll_10
L_polld_11:
    s_mov_b64 exec, -1
L_p1d_9:
    v_lshrrev_b32 v16, 3, v1
    v_mul_u32_u24 v16, 1792, v16
    v_and_b32 v17, 7, v1
    v_cmp_gt_u32 vcc, 5, v17
    v_mul_u32_u24 v17, 10752, v17
    v_add_u32 v16, v16, v17
    s_lshl_b32 s57, s7, 3
    s_add_u32 s57, s57, 8994816
    v_add_u32 v16, s57, v16
    v_mov_b32 v17, 0x80000000
    v_cndmask_b32 v16, v17, v16, vcc
    buffer_load_dwordx2 v[186:187], v16, s[36:39], 0 offen sc1
    s_waitcnt lgkmcnt(4)
    v_mfma_f32_16x16x32_bf16 v[32:35], v[128:131], v[64:67], v[32:35]
    ds_read_b64 v[140:141], v6 offset:1664
    ds_read_b64 v[142:143], v6 offset:1672
    ds_read_b128 v[96:99], v7 offset:3776
    ds_read_b128 v[100:103], v7 offset:3264
    v_and_b32 v184, 15, v1
    v_mul_u32_u24 v183, 80, v184
    v_mfma_f32_16x16x32_bf16 v[36:39], v[128:131], v[68:71], v[36:39]
    v_lshrrev_b32 v185, 4, v1
    v_lshl_add_u32 v183, v185, 4, v183
    v_mfma_f32_16x16x32_bf16 v[40:43], v[128:131], v[72:75], v[40:43]
    s_mul_i32 s72, s6, 10240
    s_add_u32 s72, s72, 90624
    v_mfma_f32_16x16x32_bf16 v[44:47], v[128:131], v[76:79], v[44:47]
    v_add_u32 v183, s72, v183
    v_mul_u32_u24 v182, 57344, v185
    v_mfma_f32_16x16x32_bf16 v[48:51], v[128:131], v[80:83], v[48:51]
    v_lshl_add_u32 v182, v184, 4, v182
    v_lshrrev_b32 v184, 2, v1
    v_mfma_f32_16x16x32_bf16 v[52:55], v[128:131], v[84:87], v[52:55]
    v_mul_u32_u24 v19, 80, v184
    v_and_b32 v185, 3, v1
    v_mfma_f32_16x16x32_bf16 v[56:59], v[128:131], v[88:91], v[56:59]
    v_lshl_add_u32 v19, v185, 4, v19
    s_mul_i32 s72, s6, 2560
    v_mfma_f32_16x16x32_bf16 v[60:63], v[128:131], v[92:95], v[60:63]
    s_add_u32 s72, s72, 90624
    v_add_u32 v19, s72, v19
    s_waitcnt lgkmcnt(6)
    v_mfma_f32_16x16x32_bf16 v[36:39], v[132:135], v[64:67], v[36:39]
    ds_read_b64 v[128:129], v6 offset:2176
    ds_read_b64 v[130:131], v6 offset:2184
    ds_read_b128 v[104:107], v7 offset:2752
    ds_read_b128 v[108:111], v7 offset:2240
    s_mul_i32 s87, s6, 458752
    s_lshl_b32 s72, s7, 8
    v_mfma_f32_16x16x32_bf16 v[40:43], v[132:135], v[68:71], v[40:43]
    s_add_u32 s87, s87, s72
    s_add_u32 s87, s87, 3948544
    v_mfma_f32_16x16x32_bf16 v[44:47], v[132:135], v[72:75], v[44:47]
    s_add_u32 s88, s87, 229376
    v_mfma_f32_16x16x32_bf16 v[48:51], v[132:135], v[76:79], v[48:51]
    v_lshlrev_b32 v174, 16, v175
    v_and_b32 v175, s80, v175
    v_mfma_f32_16x16x32_bf16 v[52:55], v[132:135], v[80:83], v[52:55]
    v_lshlrev_b32 v216, 16, v8
    v_lshlrev_b32 v232, 16, v144
    v_mfma_f32_16x16x32_bf16 v[56:59], v[132:135], v[84:87], v[56:59]
    v_lshlrev_b32 v217, 16, v9
    v_lshlrev_b32 v233, 16, v145
    v_mfma_f32_16x16x32_bf16 v[60:63], v[132:135], v[88:91], v[60:63]
    v_lshlrev_b32 v218, 16, v10
    v_lshlrev_b32 v234, 16, v146
    s_waitcnt lgkmcnt(8)
    v_mfma_f32_16x16x32_bf16 v[40:43], v[136:139], v[64:67], v[40:43]
    ds_read_b64 v[132:133], v6 offset:2688
    ds_read_b64 v[134:135], v6 offset:2696
    ds_read_b128 v[112:115], v7 offset:1728
    ds_read_b128 v[116:119], v7 offset:1216
    v_lshlrev_b32 v219, 16, v11
    v_lshlrev_b32 v235, 16, v147
    v_mfma_f32_16x16x32_bf16 v[44:47], v[136:139], v[68:71], v[44:47]
    v_and_b32 v220, s80, v8
    v_and_b32 v236, s80, v144
    v_mfma_f32_16x16x32_bf16 v[48:51], v[136:139], v[72:75], v[48:51]
    v_and_b32 v221, s80, v9
    v_and_b32 v237, s80, v145
    v_mfma_f32_16x16x32_bf16 v[52:55], v[136:139], v[76:79], v[52:55]
    v_and_b32 v222, s80, v10
    v_and_b32 v238, s80, v146
    v_mfma_f32_16x16x32_bf16 v[56:59], v[136:139], v[80:83], v[56:59]
    v_and_b32 v223, s80, v11
    v_and_b32 v239, s80, v147
    v_mfma_f32_16x16x32_bf16 v[60:63], v[136:139], v[84:87], v[60:63]
    v_lshlrev_b32 v224, 16, v12
    v_lshlrev_b32 v240, 16, v148
    s_waitcnt lgkmcnt(10)
    v_mfma_f32_16x16x32_bf16 v[44:47], v[140:143], v[64:67], v[44:47]
    ds_read_b64 v[136:137], v6 offset:3200
    ds_read_b64 v[138:139], v6 offset:3208
    ds_read_b128 v[120:123], v7 offset:704
    ds_read_b128 v[124:127], v7 offset:192
    v_lshlrev_b32 v225, 16, v13
    v_lshlrev_b32 v241, 16, v149
    v_mfma_f32_16x16x32_bf16 v[48:51], v[140:143], v[68:71], v[48:51]
    v_lshlrev_b32 v226, 16, v14
    v_lshlrev_b32 v242, 16, v150
    v_mfma_f32_16x16x32_bf16 v[52:55], v[140:143], v[72:75], v[52:55]
    v_lshlrev_b32 v227, 16, v15
    v_lshlrev_b32 v243, 16, v151
    v_mfma_f32_16x16x32_bf16 v[56:59], v[140:143], v[76:79], v[56:59]
    v_and_b32 v228, s80, v12
    v_and_b32 v244, s80, v148
    v_mfma_f32_16x16x32_bf16 v[60:63], v[140:143], v[80:83], v[60:63]
    v_and_b32 v229, s80, v13
    v_and_b32 v245, s80, v149
    s_waitcnt lgkmcnt(10)
    v_mfma_f32_16x16x32_bf16 v[48:51], v[128:131], v[64:67], v[48:51]
    ds_read_b64 v[140:141], v6 offset:3712
    ds_read_b64 v[142:143], v6 offset:3720
    v_and_b32 v230, s80, v14
    v_and_b32 v246, s80, v150
    v_mfma_f32_16x16x32_bf16 v[52:55], v[128:131], v[68:71], v[52:55]
    v_and_b32 v231, s80, v15
    v_and_b32 v247, s80, v151
    v_mfma_f32_16x16x32_bf16 v[56:59], v[128:131], v[72:75], v[56:59]
    v_pk_fma_f32 v[200:201], v[232:233], v[152:153], v[160:161] neg_lo:[0,0,1] neg_hi:[0,0,1]
    v_pk_fma_f32 v[202:203], v[234:235], v[154:155], v[162:163] neg_lo:[0,0,1] neg_hi:[0,0,1]
    s_nop 1
    v_mfma_f32_16x16x32_bf16 v[60:63], v[128:131], v[76:79], v[60:63]
    v_pk_fma_f32 v[204:205], v[236:237], v[152:153], v[160:161] neg_lo:[0,0,1] neg_hi:[0,0,1]
    v_pk_fma_f32 v[206:207], v[238:239], v[154:155], v[162:163] neg_lo:[0,0,1] neg_hi:[0,0,1]
    s_waitcnt lgkmcnt(8)
    s_nop 0
    v_mfma_f32_16x16x32_bf16 v[52:55], v[132:135], v[64:67], v[52:55]
    ds_read_b64 v[128:129], v6 offset:192
    ds_read_b64 v[130:131], v6 offset:200
    v_pk_fma_f32 v[208:209], v[240:241], v[156:157], v[164:165] neg_lo:[0,0,1] neg_hi:[0,0,1]
    v_pk_fma_f32 v[210:211], v[242:243], v[158:159], v[166:167] neg_lo:[0,0,1] neg_hi:[0,0,1]
    s_nop 1
    v_mfma_f32_16x16x32_bf16 v[56:59], v[132:135], v[68:71], v[56:59]
    v_pk_fma_f32 v[212:213], v[244:245], v[156:157], v[164:165] neg_lo:[0,0,1] neg_hi:[0,0,1]
    v_pk_fma_f32 v[214:215], v[246:247], v[158:159], v[166:167] neg_lo:[0,0,1] neg_hi:[0,0,1]
    s_nop 1
    v_mfma_f32_16x16x32_bf16 v[60:63], v[132:135], v[72:75], v[60:63]
    s_waitcnt vmcnt(0)
    v_add_f32_dpp v186, v186, v186 quad_perm:[1,0,3,2] row_mask:0xf bank_mask:0xf
    s_waitcnt lgkmcnt(6)
    v_mfma_f32_16x16x32_bf16 v[56:59], v[136:139], v[64:67], v[56:59]
    ds_read_b64 v[132:133], v6 offset:704
    ds_read_b64 v[134:135], v6 offset:712
    v_add_f32_dpp v187, v187, v187 quad_perm:[1,0,3,2] row_mask:0xf bank_mask:0xf
    v_add_f32_dpp v186, v186, v186 quad_perm:[2,3,0,1] row_mask:0xf bank_mask:0xf
    v_mfma_f32_16x16x32_bf16 v[60:63], v[136:139], v[68:71], v[60:63]
    v_add_f32_dpp v187, v187, v187 quad_perm:[2,3,0,1] row_mask:0xf bank_mask:0xf
    v_add_f32_dpp v186, v186, v186 row_half_mirror row_mask:0xf bank_mask:0xf
    s_waitcnt lgkmcnt(4)
    v_mfma_f32_16x16x32_bf16 v[60:63], v[140:143], v[64:67], v[60:63]
    ds_read_b64 v[136:137], v6 offset:1216
    ds_read_b64 v[138:139], v6 offset:1224
    v_add_f32_dpp v187, v187, v187 row_half_mirror row_mask:0xf bank_mask:0xf
    v_cvt_pk_bf16_f32 v186, v186, v187
    buffer_load_dword v20, v18, s[36:39], 0 offen sc1
    s_waitcnt lgkmcnt(4)
    v_mfma_f32_16x16x32_bf16 v[32:35], v[128:131], v[96:99], v[32:35]
    ds_read_b64 v[140:141], v6 offset:1728
    ds_read_b64 v[142:143], v6 offset:1736
    v_readlane_b32 s69, v186, 0
    v_readlane_b32 s70, v186, 8
    v_mfma_f32_16x16x32_bf16 v[36:39], v[128:131], v[100:103], v[36:39]
    v_readlane_b32 s71, v186, 16
    v_lshlrev_b32 v168, 16, s69
    v_mfma_f32_16x16x32_bf16 v[40:43], v[128:131], v[104:107], v[40:43]
    v_mov_b32 v169, s69
    v_lshlrev_b32 v170, 16, s70
    v_mfma_f32_16x16x32_bf16 v[44:47], v[128:131], v[108:111], v[44:47]
    v_mov_b32 v171, s70
    v_lshlrev_b32 v172, 16, s71
    v_mfma_f32_16x16x32_bf16 v[48:51], v[128:131], v[112:115], v[48:51]
    v_mov_b32 v173, s71
    v_and_b32 v169, s80, v169
    v_mfma_f32_16x16x32_bf16 v[52:55], v[128:131], v[116:119], v[52:55]
    v_and_b32 v171, s80, v171
    v_and_b32 v173, s80, v173
    v_mfma_f32_16x16x32_bf16 v[56:59], v[128:131], v[120:123], v[56:59]
    v_add_f32 v170, 1.0, v170
    v_add_f32 v171, 1.0, v171
    v_mfma_f32_16x16x32_bf16 v[60:63], v[128:131], v[124:127], v[60:63]
    v_cvt_pk_bf16_f32 v170, v170, v171
    v_and_b32 v171, s80, v170
    s_waitcnt lgkmcnt(4)
    v_mfma_f32_16x16x32_bf16 v[36:39], v[132:135], v[96:99], v[36:39]
    ds_read_b64 v[128:129], v6 offset:2240
    ds_read_b64 v[130:131], v6 offset:2248
    v_lshlrev_b32 v170, 16, v170
    v_mfma_f32_16x16x32_bf16 v[40:43], v[132:135], v[100:103], v[40:43]
    v_mfma_f32_16x16x32_bf16 v[44:47], v[132:135], v[104:107], v[44:47]
    v_mfma_f32_16x16x32_bf16 v[48:51], v[132:135], v[108:111], v[48:51]
    v_mfma_f32_16x16x32_bf16 v[52:55], v[132:135], v[112:115], v[52:55]
    v_mfma_f32_16x16x32_bf16 v[56:59], v[132:135], v[116:119], v[56:59]
    v_mfma_f32_16x16x32_bf16 v[60:63], v[132:135], v[120:123], v[60:63]
    s_waitcnt lgkmcnt(4)
    v_mfma_f32_16x16x32_bf16 v[40:43], v[136:139], v[96:99], v[40:43]
    ds_read_b64 v[132:133], v6 offset:2752
    ds_read_b64 v[134:135], v6 offset:2760
    v_mfma_f32_16x16x32_bf16 v[44:47], v[136:139], v[100:103], v[44:47]
    v_mfma_f32_16x16x32_bf16 v[48:51], v[136:139], v[104:107], v[48:51]
    v_mfma_f32_16x16x32_bf16 v[52:55], v[136:139], v[108:111], v[52:55]
    v_mfma_f32_16x16x32_bf16 v[56:59], v[136:139], v[112:115], v[56:59]
    v_mfma_f32_16x16x32_bf16 v[60:63], v[136:139], v[116:119], v[60:63]
    s_waitcnt lgkmcnt(4)
    v_mfma_f32_16x16x32_bf16 v[44:47], v[140:143], v[96:99], v[44:47]
    ds_read_b64 v[136:137], v6 offset:3264
    ds_read_b64 v[138:139], v6 offset:3272
    v_mfma_f32_16x16x32_bf16 v[48:51], v[140:143], v[100:103], v[48:51]
    v_mfma_f32_16x16x32_bf16 v[52:55], v[140:143], v[104:107], v[52:55]
    v_mfma_f32_16x16x32_bf16 v[56:59], v[140:143], v[108:111], v[56:59]
    v_mfma_f32_16x16x32_bf16 v[60:63], v[140:143], v[112:115], v[60:63]
    s_waitcnt lgkmcnt(4)
    v_mfma_f32_16x16x32_bf16 v[48:51], v[128:131], v[96:99], v[48:51]
    ds_read_b64 v[140:141], v6 offset:3776
    ds_read_b64 v[142:143], v6 offset:3784
    v_mfma_f32_16x16x32_bf16 v[52:55], v[128:131], v[100:103], v[52:55]
    v_mfma_f32_16x16x32_bf16 v[56:59], v[128:131], v[104:107], v[56:59]
    v_mfma_f32_16x16x32_bf16 v[60:63], v[128:131], v[108:111], v[60:63]
    s_waitcnt lgkmcnt(4)
    v_mfma_f32_16x16x32_bf16 v[52:55], v[132:135], v[96:99], v[52:55]
    v_mfma_f32_16x16x32_bf16 v[56:59], v[132:135], v[100:103], v[56:59]
    v_mfma_f32_16x16x32_bf16 v[60:63], v[132:135], v[104:107], v[60:63]
    s_waitcnt lgkmcnt(2)
    v_mfma_f32_16x16x32_bf16 v[56:59], v[136:139], v[96:99], v[56:59]
    v_mfma_f32_16x16x32_bf16 v[60:63], v[136:139], v[100:103], v[60:63]
    s_waitcnt lgkmcnt(0)
    v_mfma_f32_16x16x32_bf16 v[60:63], v[140:143], v[96:99], v[60:63]
    v_pk_fma_f32 v[200:201], v[200:201], v[170:171], v[168:169] op_sel:[0,0,0] op_sel_hi:[1,0,0]
    v_pk_fma_f32 v[202:203], v[202:203], v[170:171], v[168:169] op_sel:[0,0,0] op_sel_hi:[1,0,0]
    v_pk_fma_f32 v[204:205], v[204:205], v[170:171], v[168:169] op_sel:[0,1,1] op_sel_hi:[1,1,1]
    v_pk_fma_f32 v[206:207], v[206:207], v[170:171], v[168:169] op_sel:[0,1,1] op_sel_hi:[1,1,1]
    v_pk_fma_f32 v[208:209], v[208:209], v[170:171], v[168:169] op_sel:[0,0,0] op_sel_hi:[1,0,0]
    v_pk_fma_f32 v[210:211], v[210:211], v[170:171], v[168:169] op_sel:[0,0,0] op_sel_hi:[1,0,0]
    v_pk_fma_f32 v[212:213], v[212:213], v[170:171], v[168:169] op_sel:[0,1,1] op_sel_hi:[1,1,1]
    v_pk_fma_f32 v[214:215], v[214:215], v[170:171], v[168:169] op_sel:[0,1,1] op_sel_hi:[1,1,1]
    v_pk_mul_f32 v[200:201], v[200:201], v[172:173] op_sel:[0,0] op_sel_hi:[1,0]
    v_pk_mul_f32 v[202:203], v[202:203], v[172:173] op_sel:[0,0] op_sel_hi:[1,0]
    v_pk_mul_f32 v[204:205], v[204:205], v[172:173] op_sel:[0,1] op_sel_hi:[1,1]
    v_pk_mul_f32 v[206:207], v[206:207], v[172:173] op_sel:[0,1] op_sel_hi:[1,1]
    v_pk_mul_f32 v[208:209], v[208:209], v[172:173] op_sel:[0,0] op_sel_hi:[1,0]
    v_pk_mul_f32 v[210:211], v[210:211], v[172:173] op_sel:[0,0] op_sel_hi:[1,0]
    v_pk_mul_f32 v[212:213], v[212:213], v[172:173] op_sel:[0,1] op_sel_hi:[1,1]
    v_pk_mul_f32 v[214:215], v[214:215], v[172:173] op_sel:[0,1] op_sel_hi:[1,1]
    ds_write_b128 v183, v[32:35] offset:0
    ds_write_b128 v183, v[36:39] offset:1280
    ds_write_b128 v183, v[40:43] offset:2560
    ds_write_b128 v183, v[44:47] offset:3840
    ds_write_b128 v183, v[48:51] offset:5120
    ds_write_b128 v183, v[52:55] offset:6400
    ds_write_b128 v183, v[56:59] offset:7680
    ds_write_b128 v183, v[60:63] offset:8960
    s_waitcnt vmcnt(0)
    v_cmp_ne_u32 vcc, s56, v20
    s_nop 1
    s_cmp_eq_u64 vcc, 0
    s_cbranch_scc1 L_p1d_12
    s_mov_b32 s96, 0
L_poll_13:
    buffer_load_dword v20, v18, s[36:39], 0 offen sc1
    s_waitcnt vmcnt(0)
    v_cmp_ne_u32 vcc, s56, v20
    s_add_u32 s96, s96, 1
    s_nop 3
    s_cmp_eq_u64 vcc, 0
    s_cbranch_scc1 L_polld_14
    s_mov_b64 exec, vcc
    s_cmp_lt_u32 s96, 131072
    s_cbranch_scc1 L_poll_13
L_polld_14:
    s_mov_b64 exec, -1
L_p1d_12:
    s_waitcnt lgkmcnt(0)
    s_barrier
    ds_read_b128 v[96:99], v19 offset:0
    ds_read_b128 v[100:103], v19 offset:10240
    ds_read_b128 v[104:107], v19 offset:20480
    ds_read_b128 v[108:111], v19 offset:30720
    ds_read_b128 v[112:115], v19 offset:1280
    ds_read_b128 v[116:119], v19 offset:11520
    ds_read_b128 v[120:123], v19 offset:21760
    ds_read_b128 v[124:127], v19 offset:32000
    s_waitcnt lgkmcnt(4)
    v_pk_add_f32 v[96:97], v[96:97], v[100:101]
    v_pk_add_f32 v[98:99], v[98:99], v[102:103]
    v_pk_add_f32 v[104:105], v[104:105], v[108:109]
    v_pk_add_f32 v[106:107], v[106:107], v[110:111]
    v_pk_fma_f32 v[96:97], v[216:217], v[174:175], v[96:97] op_sel:[0,0,0] op_sel_hi:[1,0,1]
    v_pk_fma_f32 v[98:99], v[218:219], v[174:175], v[98:99] op_sel:[0,0,0] op_sel_hi:[1,0,1]
    v_pk_fma_f32 v[104:105], v[220:221], v[174:175], v[104:105] op_sel:[0,1,0] op_sel_hi:[1,1,1]
    v_pk_fma_f32 v[106:107], v[222:223], v[174:175], v[106:107] op_sel:[0,1,0] op_sel_hi:[1,1,1]
    v_pk_fma_f32 v[96:97], v[200:201], v[96:97], v[232:233]
    v_pk_fma_f32 v[98:99], v[202:203], v[98:99], v[234:235]
    v_pk_fma_f32 v[104:105], v[204:205], v[104:105], v[236:237]
    v_pk_fma_f32 v[106:107], v[206:207], v[106:107], v[238:239]
    v_cvt_pk_bf16_f32 v128, v96, v104
    v_cvt_pk_bf16_f32 v129, v97, v105
    v_cvt_pk_bf16_f32 v130, v98, v106
    v_cvt_pk_bf16_f32 v131, v99, v107
    buffer_store_dwordx4 v[128:131], v182, s[36:39], s87 offen sc1
    s_waitcnt lgkmcnt(0)
    v_pk_add_f32 v[112:113], v[112:113], v[116:117]
    v_pk_add_f32 v[114:115], v[114:115], v[118:119]
    v_pk_add_f32 v[120:121], v[120:121], v[124:125]
    v_pk_add_f32 v[122:123], v[122:123], v[126:127]
    v_pk_fma_f32 v[112:113], v[224:225], v[174:175], v[112:113] op_sel:[0,0,0] op_sel_hi:[1,0,1]
    v_pk_fma_f32 v[114:115], v[226:227], v[174:175], v[114:115] op_sel:[0,0,0] op_sel_hi:[1,0,1]
    v_pk_fma_f32 v[120:121], v[228:229], v[174:175], v[120:121] op_sel:[0,1,0] op_sel_hi:[1,1,1]
    v_pk_fma_f32 v[122:123], v[230:231], v[174:175], v[122:123] op_sel:[0,1,0] op_sel_hi:[1,1,1]
    v_pk_fma_f32 v[112:113], v[208:209], v[112:113], v[240:241]
    v_pk_fma_f32 v[114:115], v[210:211], v[114:115], v[242:243]
    v_pk_fma_f32 v[120:121], v[212:213], v[120:121], v[244:245]
    v_pk_fma_f32 v[122:123], v[214:215], v[122:123], v[246:247]
    v_cvt_pk_bf16_f32 v132, v112, v120
    v_cvt_pk_bf16_f32 v133, v113, v121
    v_cvt_pk_bf16_f32 v134, v114, v122
    v_cvt_pk_bf16_f32 v135, v115, v123
    buffer_store_dwordx4 v[132:135], v182, s[36:39], s88 offen sc1
    s_lshl_b32 s57, s7, 7
    s_add_u32 s57, s57, 73728
    s_barrier
    v_lshlrev_b32 v16, 3, v0
    s_mov_b32 s58, 9001984
    s_mov_b32 s59, 9000192
    buffer_load_dwordx2 v[188:189], v16, s[36:39], s58 offen sc1
    buffer_load_dwordx2 v[190:191], v16, s[36:39], s59 offen sc1
    s_mov_b32 s58, 9012736
    s_mov_b32 s59, 9010944
    buffer_load_dwordx2 v[192:193], v16, s[36:39], s58 offen sc1
    buffer_load_dwordx2 v[194:195], v16, s[36:39], s59 offen sc1
    s_mov_b32 s58, 9023488
    s_mov_b32 s59, 9021696
    buffer_load_dwordx2 v[196:197], v16, s[36:39], s58 offen sc1
    buffer_load_dwordx2 v[198:199], v16, s[36:39], s59 offen sc1
    s_mov_b32 s58, 9034240
    s_mov_b32 s59, 9032448
    buffer_load_dwordx2 v[200:201], v16, s[36:39], s58 offen sc1
    buffer_load_dwordx2 v[202:203], v16, s[36:39], s59 offen sc1
    s_mov_b32 s58, 9044992
    s_mov_b32 s59, 9043200
    buffer_load_dwordx2 v[204:205], v16, s[36:39], s58 offen sc1
    buffer_load_dwordx2 v[206:207], v16, s[36:39], s59 offen sc1
    v_lshlrev_b32 v17, 2, v1
    s_lshl_b32 s60, s5, 8
    s_add_u32 s58, s60, 9003776
    buffer_load_dword v208, v17, s[36:39], s58 offen sc1
    s_add_u32 s58, s60, 9014528
    buffer_load_dword v209, v17, s[36:39], s58 offen sc1
    s_add_u32 s58, s60, 9025280
    buffer_load_dword v210, v17, s[36:39], s58 offen sc1
    s_add_u32 s58, s60, 9036032
    buffer_load_dword v211, v17, s[36:39], s58 offen sc1
    s_add_u32 s58, s60, 9046784
    buffer_load_dword v212, v17, s[36:39], s58 offen sc1
    buffer_load_dwordx4 a[0:3], v3, s[36:39], s78 offen offset:0 sc1
    buffer_load_dwordx4 a[4:7], v3, s[36:39], s78 offen offset:1024 sc1
    buffer_load_dwordx4 a[8:11], v3, s[36:39], s78 offen offset:2048 sc1
    buffer_load_dwordx4 a[12:15], v3, s[36:39], s78 offen offset:3072 sc1
    s_add_u32 s78, s78, 4096
    buffer_load_dwordx4 a[16:19], v3, s[36:39], s78 offen offset:0 sc1
    buffer_load_dwordx4 a[20:23], v3, s[36:39], s78 offen offset:1024 sc1
    buffer_load_dwordx4 a[24:27], v3, s[36:39], s78 offen offset:2048 sc1
    buffer_load_dwordx4 a[28:31], v3, s[36:39], s78 offen offset:3072 sc1
    s_add_u32 s78, s78, 4096
    buffer_load_dwordx4 a[32:35], v3, s[36:39], s78 offen offset:0 sc1
    buffer_load_dwordx4 a[36:39], v3, s[36:39], s78 offen offset:1024 sc1
    buffer_load_dwordx4 a[40:43], v3, s[36:39], s78 offen offset:2048 sc1
    buffer_load_dwordx4 a[44:47], v3, s[36:39], s78 offen offset:3072 sc1
    s_add_u32 s78, s78, 4096
    buffer_load_dwordx4 a[48:51], v3, s[36:39], s78 offen offset:0 sc1
    buffer_load_dwordx4 a[52:55], v3, s[36:39], s78 offen offset:1024 sc1
    buffer_load_dwordx4 a[56:59], v3, s[36:39], s78 offen offset:2048 sc1
    buffer_load_dwordx4 a[60:63], v3, s[36:39], s78 offen offset:3072 sc1
    s_add_u32 s78, s78, 4096
    buffer_load_dwordx4 a[64:67], v3, s[36:39], s78 offen offset:0 sc1
    buffer_load_dwordx4 a[68:71], v3, s[36:39], s78 offen offset:1024 sc1
    buffer_load_dwordx4 a[72:75], v3, s[36:39], s78 offen offset:2048 sc1
    buffer_load_dwordx4 a[76:79], v3, s[36:39], s78 offen offset:3072 sc1
    s_add_u32 s78, s78, 4096
    buffer_load_dwordx4 a[80:83], v3, s[36:39], s78 offen offset:0 sc1
    buffer_load_dwordx4 a[84:87], v3, s[36:39], s78 offen offset:1024 sc1
    buffer_load_dwordx4 a[88:91], v3, s[36:39], s78 offen offset:2048 sc1
    buffer_load_dwordx4 a[92:95], v3, s[36:39], s78 offen offset:3072 sc1
    s_waitcnt vmcnt(24)
    v_pk_add_f32 v[188:189], v[188:189], v[192:193]
    v_pk_add_f32 v[190:191], v[190:191], v[194:195]
    v_add_f32 v208, v208, v209
    v_pk_add_f32 v[196:197], v[196:197], v[200:201]
    v_pk_add_f32 v[198:199], v[198:199], v[202:203]
    v_add_f32 v210, v210, v211
    v_pk_add_f32 v[188:189], v[188:189], v[196:197]
    v_pk_add_f32 v[190:191], v[190:191], v[198:199]
    v_add_f32 v208, v208, v210
    v_pk_add_f32 v[188:189], v[188:189], v[204:205]
    v_pk_add_f32 v[190:191], v[190:191], v[206:207]
    v_add_f32 v208, v208, v212
    v_cvt_pk_bf16_f32 v176, v188, v189
    v_cvt_pk_bf16_f32 v178, v190, v191
    v_cvt_pk_bf16_f32 v180, v208, v208
    v_and_b32 v177, s80, v176
    v_lshlrev_b32 v176, 16, v176
    v_and_b32 v179, s80, v178
    v_lshlrev_b32 v178, 16, v178
    v_and_b32 v180, s80, v180
    v_add_f32 v176, 1.0, v176
    v_add_f32 v177, 1.0, v177
    v_cvt_pk_bf16_f32 v176, v176, v177
    v_and_b32 v177, s80, v176
    v_lshlrev_b32 v176, 16, v176
    s_mov_b32 s59, 0x3fb8aa3b
    v_lshlrev_b32 v16, 4, v0
    v_add_u32 v16, 131584, v16
    v_lshlrev_b32 v17, 2, v1
    v_add_u32 v17, 137728, v17
    v_mul_f32 v176, s59, v176
    v_mul_f32 v177, s59, v177
    v_mul_f32 v178, s59, v178
    v_mul_f32 v179, s59, v179
    ds_write_b128 v16, v[176:179]
    ds_write_b32 v17, v180
    v_min_u32 v2, 55, v1
    s_mul_i32 s57, s6, 56
    v_add_u32 v2, s57, v2
    v_lshlrev_b32 v2, 8, v2
    s_mul_i32 s57, s4, 57344
    s_add_u32 s57, s57, 3948544
    v_add_u32 v2, s57, v2
    v_mov_b32 v251, v2
    s_lshr_b32 s57, s6, 1
    s_lshl_b32 s57, s57, 10
    v_add_u32 v2, s57, v3
    s_sub_u32 s57, 1024, s57
    v_add_u32 v253, s57, v3
    s_mov_b32 s92, 0
    s_mov_b32 s85, s78
L_xretry_15:
    s_mov_b32 s78, s85
    v_lshlrev_b32 v4, 4, v1
    s_mul_i32 s58, s6, 14336
    s_mul_i32 s57, s4, 57344
    s_add_u32 s57, s57, s58
    s_add_u32 s57, s57, 3948544
    s_add_u32 s58, s58, 69632
    s_mov_b32 m0, s58
    s_nop 0
    buffer_load_dwordx4 v4, s[36:39], s57 offen offset:0 sc1 lds
    buffer_load_dwordx4 v4, s[36:39], s57 offen offset:1024 sc1 lds
    buffer_load_dwordx4 v4, s[36:39], s57 offen offset:2048 sc1 lds
    buffer_load_dwordx4 v4, s[36:39], s57 offen offset:3072 sc1 lds
    s_add_u32 s57, s57, 4096
    s_add_u32 m0, m0, 4096
    s_nop 0
    buffer_load_dwordx4 v4, s[36:39], s57 offen offset:0 sc1 lds
    buffer_load_dwordx4 v4, s[36:39], s57 offen offset:1024 sc1 lds
    buffer_load_dwordx4 v4, s[36:39], s57 offen offset:2048 sc1 lds
    buffer_load_dwordx4 v4, s[36:39], s57 offen offset:3072 sc1 lds
    s_add_u32 s57, s57, 4096
    s_add_u32 m0, m0, 4096
    s_nop 0
    buffer_load_dwordx4 v4, s[36:39], s57 offen offset:0 sc1 lds
    buffer_load_dwordx4 v4, s[36:39], s57 offen offset:1024 sc1 lds
    buffer_load_dwordx4 v4, s[36:39], s57 offen offset:2048 sc1 lds
    buffer_load_dwordx4 v4, s[36:39], s57 offen offset:3072 sc1 lds
    s_add_u32 s57, s57, 4096
    s_add_u32 m0, m0, 4096
    s_nop 0
    buffer_load_dwordx4 v4, s[36:39], s57 offen offset:0 sc1 lds
    buffer_load_dwordx4 v4, s[36:39], s57 offen offset:1024 sc1 lds
    v_lshlrev_b32 v5, 2, v1
    v_add_u32 v5, s58, v5
    s_waitcnt vmcnt(13)
    ds_read2st64_b32 v[72:73], v5 offset0:0 offset1:1
    ds_read2st64_b32 v[74:75], v5 offset0:2 offset1:3
    s_waitcnt vmcnt(12)
    ds_read2st64_b32 v[76:77], v5 offset0:4 offset1:5
    ds_read2st64_b32 v[78:79], v5 offset0:6 offset1:7
    s_waitcnt vmcnt(11)
    ds_read2st64_b32 v[80:81], v5 offset0:8 offset1:9
    ds_read2st64_b32 v[82:83], v5 offset0:10 offset1:11
    s_waitcnt lgkmcnt(4)
    s_waitcnt vmcnt(10)
    ds_read2st64_b32 v[84:85], v5 offset0:12 offset1:13
    ds_read2st64_b32 v[86:87], v5 offset0:14 offset1:15
    v_lshlrev_b32 v88, 16, v72
    v_and_b32 v89, s80, v72
    v_lshlrev_b32 v90, 16, v73
    v_and_b32 v91, s80, v73
    v_lshlrev_b32 v92, 16, v74
    v_and_b32 v93, s80, v74
    v_lshlrev_b32 v94, 16, v75
    v_and_b32 v95, s80, v75
    v_mov_b32 v8, v88
    v_mov_b32 v9, v89
    v_pk_mul_f32 v[12:13], v[88:89], v[88:89]
    v_mov_b32 v10, v90
    v_mov_b32 v11, v91
    v_pk_mul_f32 v[14:15], v[90:91], v[90:91]
    v_pk_add_f32 v[8:9], v[8:9], v[92:93]
    v_pk_fma_f32 v[12:13], v[92:93], v[92:93], v[12:13]
    v_pk_add_f32 v[10:11], v[10:11], v[94:95]
    v_pk_fma_f32 v[14:15], v[94:95], v[94:95], v[14:15]
    s_waitcnt lgkmcnt(4)
    s_waitcnt vmcnt(9)
    ds_read2st64_b32 v[72:73], v5 offset0:16 offset1:17
    ds_read2st64_b32 v[74:75], v5 offset0:18 offset1:19
    v_lshlrev_b32 v96, 16, v76
    v_and_b32 v97, s80, v76
    v_lshlrev_b32 v98, 16, v77
    v_and_b32 v99, s80, v77
    v_lshlrev_b32 v100, 16, v78
    v_and_b32 v101, s80, v78
    v_lshlrev_b32 v102, 16, v79
    v_and_b32 v103, s80, v79
    v_pk_add_f32 v[8:9], v[8:9], v[96:97]
    v_pk_fma_f32 v[12:13], v[96:97], v[96:97], v[12:13]
    v_pk_add_f32 v[10:11], v[10:11], v[98:99]
    v_pk_fma_f32 v[14:15], v[98:99], v[98:99], v[14:15]
    v_pk_add_f32 v[8:9], v[8:9], v[100:101]
    v_pk_fma_f32 v[12:13], v[100:101], v[100:101], v[12:13]
    v_pk_add_f32 v[10:11], v[10:11], v[102:103]
    v_pk_fma_f32 v[14:15], v[102:103], v[102:103], v[14:15]
    s_waitcnt lgkmcnt(4)
    s_waitcnt vmcnt(8)
    ds_read2st64_b32 v[76:77], v5 offset0:20 offset1:21
    ds_read2st64_b32 v[78:79], v5 offset0:22 offset1:23
    v_lshlrev_b32 v104, 16, v80
    v_and_b32 v105, s80, v80
    v_lshlrev_b32 v106, 16, v81
    v_and_b32 v107, s80, v81
    v_lshlrev_b32 v108, 16, v82
    v_and_b32 v109, s80, v82
    v_lshlrev_b32 v110, 16, v83
    v_and_b32 v111, s80, v83
    v_pk_add_f32 v[8:9], v[8:9], v[104:105]
    v_pk_fma_f32 v[12:13], v[104:105], v[104:105], v[12:13]
    v_pk_add_f32 v[10:11], v[10:11], v[106:107]
    v_pk_fma_f32 v[14:15], v[106:107], v[106:107], v[14:15]
    v_pk_add_f32 v[8:9], v[8:9], v[108:109]
    v_pk_fma_f32 v[12:13], v[108:109], v[108:109], v[12:13]
    v_pk_add_f32 v[10:11], v[10:11], v[110:111]
    v_pk_fma_f32 v[14:15], v[110:111], v[110:111], v[14:15]
    s_waitcnt lgkmcnt(4)
    s_waitcnt vmcnt(7)
    ds_read2st64_b32 v[80:81], v5 offset0:24 offset1:25
    ds_read2st64_b32 v[82:83], v5 offset0:26 offset1:27
    v_lshlrev_b32 v112, 16, v84
    v_and_b32 v113, s80, v84
    v_lshlrev_b32 v114, 16, v85
    v_and_b32 v115, s80, v85
    v_lshlrev_b32 v116, 16, v86
    v_and_b32 v117, s80, v86
    v_lshlrev_b32 v118, 16, v87
    v_and_b32 v119, s80, v87
    v_pk_add_f32 v[8:9], v[8:9], v[112:113]
    v_pk_fma_f32 v[12:13], v[112:113], v[112:113], v[12:13]
    v_pk_add_f32 v[10:11], v[10:11], v[114:115]
    v_pk_fma_f32 v[14:15], v[114:115], v[114:115], v[14:15]
    v_pk_add_f32 v[8:9], v[8:9], v[116:117]
    v_pk_fma_f32 v[12:13], v[116:117], v[116:117], v[12:13]
    v_pk_add_f32 v[10:11], v[10:11], v[118:119]
    v_pk_fma_f32 v[14:15], v[118:119], v[118:119], v[14:15]
    s_add_u32 s78, s78, 4096
    buffer_load_dwordx4 a[96:99], v3, s[36:39], s78 offen offset:0 sc1
    s_waitcnt lgkmcnt(4)
    s_waitcnt vmcnt(7)
    ds_read2st64_b32 v[84:85], v5 offset0:28 offset1:29
    ds_read2st64_b32 v[86:87], v5 offset0:30 offset1:31
    v_lshlrev_b32 v120, 16, v72
    v_and_b32 v121, s80, v72
    v_lshlrev_b32 v122, 16, v73
    v_and_b32 v123, s80, v73
    v_lshlrev_b32 v124, 16, v74
    v_and_b32 v125, s80, v74
    v_lshlrev_b32 v126, 16, v75
    v_and_b32 v127, s80, v75
    v_pk_add_f32 v[8:9], v[8:9], v[120:121]
    v_pk_fma_f32 v[12:13], v[120:121], v[120:121], v[12:13]
    v_pk_add_f32 v[10:11], v[10:11], v[122:123]
    v_pk_fma_f32 v[14:15], v[122:123], v[122:123], v[14:15]
    v_pk_add_f32 v[8:9], v[8:9], v[124:125]
    v_pk_fma_f32 v[12:13], v[124:125], v[124:125], v[12:13]
    v_pk_add_f32 v[10:11], v[10:11], v[126:127]
    v_pk_fma_f32 v[14:15], v[126:127], v[126:127], v[14:15]
    buffer_load_dwordx4 a[100:103], v3, s[36:39], s78 offen offset:1024 sc1
    s_waitcnt lgkmcnt(4)
    s_waitcnt vmcnt(7)
    ds_read2st64_b32 v[72:73], v5 offset0:32 offset1:33
    ds_read2st64_b32 v[74:75], v5 offset0:34 offset1:35
    v_lshlrev_b32 v128, 16, v76
    v_and_b32 v129, s80, v76
    v_lshlrev_b32 v130, 16, v77
    v_and_b32 v131, s80, v77
    v_lshlrev_b32 v132, 16, v78
    v_and_b32 v133, s80, v78
    v_lshlrev_b32 v134, 16, v79
    v_and_b32 v135, s80, v79
    v_pk_add_f32 v[8:9], v[8:9], v[128:129]
    v_pk_fma_f32 v[12:13], v[128:129], v[128:129], v[12:13]
    v_pk_add_f32 v[10:11], v[10:11], v[130:131]
    v_pk_fma_f32 v[14:15], v[130:131], v[130:131], v[14:15]
    v_pk_add_f32 v[8:9], v[8:9], v[132:133]
    v_pk_fma_f32 v[12:13], v[132:133], v[132:133], v[12:13]
    v_pk_add_f32 v[10:11], v[10:11], v[134:135]
    v_pk_fma_f32 v[14:15], v[134:135], v[134:135], v[14:15]
    buffer_load_dwordx4 a[104:107], v3, s[36:39], s78 offen offset:2048 sc1
    s_waitcnt lgkmcnt(4)
    s_waitcnt vmcnt(7)
    ds_read2st64_b32 v[76:77], v5 offset0:36 offset1:37
    ds_read2st64_b32 v[78:79], v5 offset0:38 offset1:39
    v_lshlrev_b32 v136, 16, v80
    v_and_b32 v137, s80, v80
    v_lshlrev_b32 v138, 16, v81
    v_and_b32 v139, s80, v81
    v_lshlrev_b32 v140, 16, v82
    v_and_b32 v141, s80, v82
    v_lshlrev_b32 v142, 16, v83
    v_and_b32 v143, s80, v83
    v_pk_add_f32 v[8:9], v[8:9], v[136:137]
    v_pk_fma_f32 v[12:13], v[136:137], v[136:137], v[12:13]
    v_pk_add_f32 v[10:11], v[10:11], v[138:139]
    v_pk_fma_f32 v[14:15], v[138:139], v[138:139], v[14:15]
    v_pk_add_f32 v[8:9], v[8:9], v[140:141]
    v_pk_fma_f32 v[12:13], v[140:141], v[140:141], v[12:13]
    v_pk_add_f32 v[10:11], v[10:11], v[142:143]
    v_pk_fma_f32 v[14:15], v[142:143], v[142:143], v[14:15]
    buffer_load_dwordx4 a[108:111], v3, s[36:39], s78 offen offset:3072 sc1
    s_waitcnt lgkmcnt(4)
    s_waitcnt vmcnt(7)
    ds_read2st64_b32 v[80:81], v5 offset0:40 offset1:41
    ds_read2st64_b32 v[82:83], v5 offset0:42 offset1:43
    v_lshlrev_b32 v144, 16, v84
    v_and_b32 v145, s80, v84
    v_lshlrev_b32 v146, 16, v85
    v_and_b32 v147, s80, v85
    v_lshlrev_b32 v148, 16, v86
    v_and_b32 v149, s80, v86
    v_lshlrev_b32 v150, 16, v87
    v_and_b32 v151, s80, v87
    v_pk_add_f32 v[8:9], v[8:9], v[144:145]
    v_pk_fma_f32 v[12:13], v[144:145], v[144:145], v[12:13]
    v_pk_add_f32 v[10:11], v[10:11], v[146:147]
    v_pk_fma_f32 v[14:15], v[146:147], v[146:147], v[14:15]
    v_pk_add_f32 v[8:9], v[8:9], v[148:149]
    v_pk_fma_f32 v[12:13], v[148:149], v[148:149], v[12:13]
    v_pk_add_f32 v[10:11], v[10:11], v[150:151]
    v_pk_fma_f32 v[14:15], v[150:151], v[150:151], v[14:15]
    s_add_u32 s78, s78, 4096
    buffer_load_dwordx4 a[112:115], v3, s[36:39], s78 offen offset:0 sc1
    s_waitcnt lgkmcnt(4)
    s_waitcnt vmcnt(7)
    ds_read2st64_b32 v[84:85], v5 offset0:44 offset1:45
    ds_read2st64_b32 v[86:87], v5 offset0:46 offset1:47
    v_lshlrev_b32 v152, 16, v72
    v_and_b32 v153, s80, v72
    v_lshlrev_b32 v154, 16, v73
    v_and_b32 v155, s80, v73
    v_lshlrev_b32 v156, 16, v74
    v_and_b32 v157, s80, v74
    v_lshlrev_b32 v158, 16, v75
    v_and_b32 v159, s80, v75
    v_pk_add_f32 v[8:9], v[8:9], v[152:153]
    v_pk_fma_f32 v[12:13], v[152:153], v[152:153], v[12:13]
    v_pk_add_f32 v[10:11], v[10:11], v[154:155]
    v_pk_fma_f32 v[14:15], v[154:155], v[154:155], v[14:15]
    v_pk_add_f32 v[8:9], v[8:9], v[156:157]
    v_pk_fma_f32 v[12:13], v[156:157], v[156:157], v[12:13]
    v_pk_add_f32 v[10:11], v[10:11], v[158:159]
    v_pk_fma_f32 v[14:15], v[158:159], v[158:159], v[14:15]
    buffer_load_dwordx4 a[116:119], v3, s[36:39], s78 offen offset:1024 sc1
    s_waitcnt lgkmcnt(4)
    s_waitcnt vmcnt(7)
    ds_read2st64_b32 v[72:73], v5 offset0:48 offset1:49
    ds_read2st64_b32 v[74:75], v5 offset0:50 offset1:51
    v_lshlrev_b32 v160, 16, v76
    v_and_b32 v161, s80, v76
    v_lshlrev_b32 v162, 16, v77
    v_and_b32 v163, s80, v77
    v_lshlrev_b32 v164, 16, v78
    v_and_b32 v165, s80, v78
    v_lshlrev_b32 v166, 16, v79
    v_and_b32 v167, s80, v79
    v_pk_add_f32 v[8:9], v[8:9], v[160:161]
    v_pk_fma_f32 v[12:13], v[160:161], v[160:161], v[12:13]
    v_pk_add_f32 v[10:11], v[10:11], v[162:163]
    v_pk_fma_f32 v[14:15], v[162:163], v[162:163], v[14:15]
    v_pk_add_f32 v[8:9], v[8:9], v[164:165]
    v_pk_fma_f32 v[12:13], v[164:165], v[164:165], v[12:13]
    v_pk_add_f32 v[10:11], v[10:11], v[166:167]
    v_pk_fma_f32 v[14:15], v[166:167], v[166:167], v[14:15]
    buffer_load_dwordx4 a[120:123], v3, s[36:39], s78 offen offset:2048 sc1
    s_waitcnt lgkmcnt(4)
    s_waitcnt vmcnt(7)
    ds_read2st64_b32 v[76:77], v5 offset0:52 offset1:53
    ds_read2st64_b32 v[78:79], v5 offset0:54 offset1:55
    v_lshlrev_b32 v168, 16, v80
    v_and_b32 v169, s80, v80
    v_lshlrev_b32 v170, 16, v81
    v_and_b32 v171, s80, v81
    v_lshlrev_b32 v172, 16, v82
    v_and_b32 v173, s80, v82
    v_lshlrev_b32 v174, 16, v83
    v_and_b32 v175, s80, v83
    v_pk_add_f32 v[8:9], v[8:9], v[168:169]
    v_pk_fma_f32 v[12:13], v[168:169], v[168:169], v[12:13]
    v_pk_add_f32 v[10:11], v[10:11], v[170:171]
    v_pk_fma_f32 v[14:15], v[170:171], v[170:171], v[14:15]
    v_pk_add_f32 v[8:9], v[8:9], v[172:173]
    v_pk_fma_f32 v[12:13], v[172:173], v[172:173], v[12:13]
    v_pk_add_f32 v[10:11], v[10:11], v[174:175]
    v_pk_fma_f32 v[14:15], v[174:175], v[174:175], v[14:15]
    buffer_load_dwordx4 a[124:127], v3, s[36:39], s78 offen offset:3072 sc1
    s_waitcnt lgkmcnt(4)
    v_lshlrev_b32 v176, 16, v84
    v_and_b32 v177, s80, v84
    v_lshlrev_b32 v178, 16, v85
    v_and_b32 v179, s80, v85
    v_lshlrev_b32 v180, 16, v86
    v_and_b32 v181, s80, v86
    v_lshlrev_b32 v182, 16, v87
    v_and_b32 v183, s80, v87
    v_pk_add_f32 v[8:9], v[8:9], v[176:177]
    v_pk_fma_f32 v[12:13], v[176:177], v[176:177], v[12:13]
    v_pk_add_f32 v[10:11], v[10:11], v[178:179]
    v_pk_fma_f32 v[14:15], v[178:179], v[178:179], v[14:15]
    v_pk_add_f32 v[8:9], v[8:9], v[180:181]
    v_pk_fma_f32 v[12:13], v[180:181], v[180:181], v[12:13]
    v_pk_add_f32 v[10:11], v[10:11], v[182:183]
    v_pk_fma_f32 v[14:15], v[182:183], v[182:183], v[14:15]
    s_add_u32 s78, s78, 4096
    buffer_load_dwordx4 a[128:131], v3, s[36:39], s78 offen offset:0 sc1
    s_waitcnt lgkmcnt(2)
    v_lshlrev_b32 v184, 16, v72
    v_and_b32 v185, s80, v72
    v_lshlrev_b32 v186, 16, v73
    v_and_b32 v187, s80, v73
    v_lshlrev_b32 v188, 16, v74
    v_and_b32 v189, s80, v74
    v_lshlrev_b32 v190, 16, v75
    v_and_b32 v191, s80, v75
    v_pk_add_f32 v[8:9], v[8:9], v[184:185]
    v_pk_fma_f32 v[12:13], v[184:185], v[184:185], v[12:13]
    v_pk_add_f32 v[10:11], v[10:11], v[186:187]
    v_pk_fma_f32 v[14:15], v[186:187], v[186:187], v[14:15]
    v_pk_add_f32 v[8:9], v[8:9], v[188:189]
    v_pk_fma_f32 v[12:13], v[188:189], v[188:189], v[12:13]
    v_pk_add_f32 v[10:11], v[10:11], v[190:191]
    v_pk_fma_f32 v[14:15], v[190:191], v[190:191], v[14:15]
    buffer_load_dwordx4 a[132:135], v3, s[36:39], s78 offen offset:1024 sc1
    s_waitcnt lgkmcnt(0)
    v_lshlrev_b32 v192, 16, v76
    v_and_b32 v193, s80, v76
    v_lshlrev_b32 v194, 16, v77
    v_and_b32 v195, s80, v77
    v_lshlrev_b32 v196, 16, v78
    v_and_b32 v197, s80, v78
    v_lshlrev_b32 v198, 16, v79
    v_and_b32 v199, s80, v79
    v_pk_add_f32 v[8:9], v[8:9], v[192:193]
    v_pk_fma_f32 v[12:13], v[192:193], v[192:193], v[12:13]
    v_pk_add_f32 v[10:11], v[10:11], v[194:195]
    v_pk_fma_f32 v[14:15], v[194:195], v[194:195], v[14:15]
    v_pk_add_f32 v[8:9], v[8:9], v[196:197]
    v_pk_fma_f32 v[12:13], v[196:197], v[196:197], v[12:13]
    v_pk_add_f32 v[10:11], v[10:11], v[198:199]
    v_pk_fma_f32 v[14:15], v[198:199], v[198:199], v[14:15]
    buffer_load_dwordx4 a[136:139], v3, s[36:39], s78 offen offset:2048 sc1
    v_pk_add_f32 v[8:9], v[8:9], v[10:11]
    v_pk_add_f32 v[12:13], v[12:13], v[14:15]
    v_add_f32 v8, v8, v9
    v_add_f32 v9, v12, v13
    v_cmp_u_f32 vcc, v8, v8
    s_add_u32 s92, s92, 1
    s_nop 1
    s_cmp_eq_u64 vcc, 0
    s_cbranch_scc1 L_xok_16
    s_cmp_ge_u32 s92, 4096
    s_cbranch_scc1 L_xok_16
    s_waitcnt vmcnt(0) lgkmcnt(0)
    s_mov_b32 s96, 0
L_poll_17:
    buffer_load_dword v4, v251, s[36:39], 0 offen sc1
    s_waitcnt vmcnt(0)
    v_cmp_eq_u32 vcc, -1, v4
    s_add_u32 s96, s96, 1
    s_nop 3
    s_cmp_eq_u64 vcc, 0
    s_cbranch_scc1 L_polld_18
    s_mov_b64 exec, vcc
    s_cmp_lt_u32 s96, 131072
    s_cbranch_scc1 L_poll_17
L_polld_18:
    s_mov_b64 exec, -1
    s_cmp_ge_u32 s96, 131072
    s_cselect_b32 s92, 4096, s92
    s_branch L_xretry_15
L_xok_16:
    v_lshlrev_b32 v5, 3, v1
    v_add_u32 v5, 135680, v5
    s_lshl_b32 s57, s6, 9
    v_add_u32 v6, s57, v5
    ds_write_b64 v6, v[8:9]
    v_lshrrev_b32 v22, 5, v1
    v_lshlrev_b32 v7, 10, v22
    v_and_b32 v22, 31, v1
    v_lshl_add_u32 v7, v22, 4, v7
    s_mul_i32 s57, s6, 14336
    v_add_u32 v7, s57, v7
    s_mul_i32 s57, s6, 896
    s_add_u32 s57, s57, 131584
    s_waitcnt lgkmcnt(0)
    s_barrier
    ds_read_b64 v[16:17], v5 offset:0
    ds_read_b64 v[18:19], v5 offset:512
    ds_read_b64 v[20:21], v5 offset:1024
    ds_read_b64 v[22:23], v5 offset:1536
    v_mov_b32 v6, s57
    ds_read_b128 v[24:27], v6 offset:0
    ds_read_b128 v[28:31], v6 offset:16
    ds_read_b128 v[32:35], v6 offset:32
    ds_read_b128 v[36:39], v6 offset:48
    ds_read_b128 v[40:43], v6 offset:64
    ds_read_b128 v[44:47], v6 offset:80
    ds_read_b128 v[48:51], v6 offset:96
    ds_read_b128 v[52:55], v6 offset:112
    s_waitcnt lgkmcnt(10)
    v_pk_add_f32 v[16:17], v[16:17], v[18:19]
    s_waitcnt lgkmcnt(8)
    v_pk_add_f32 v[20:21], v[20:21], v[22:23]
    v_pk_add_f32 v[16:17], v[16:17], v[20:21]
    s_mov_b32 s57, 0x3b124925
    s_mov_b32 s58, 0x3727c5ac
    v_mul_f32 v16, s57, v16
    v_mul_f32 v17, s57, v17
    v_fma_f32 v17, -v16, v16, v17
    v_max_f32 v17, 0, v17
    v_add_f32 v17, s58, v17
    v_rsq_f32 v18, v17
    s_nop 0
    v_mul_f32 v20, v16, v18
    s_waitcnt lgkmcnt(4)
    ds_read_b128 v[72:75], v6 offset:128
    ds_read_b128 v[76:79], v6 offset:144
    ds_read_b128 v[80:83], v6 offset:160
    ds_read_b128 v[84:87], v6 offset:176
    v_pk_fma_f32 v[88:89], v[88:89], v[18:19], v[20:21] op_sel_hi:[1,0,0] neg_lo:[0,0,1] neg_hi:[0,0,1]
    v_pk_fma_f32 v[90:91], v[90:91], v[18:19], v[20:21] op_sel_hi:[1,0,0] neg_lo:[0,0,1] neg_hi:[0,0,1]
    v_pk_fma_f32 v[92:93], v[92:93], v[18:19], v[20:21] op_sel_hi:[1,0,0] neg_lo:[0,0,1] neg_hi:[0,0,1]
    v_pk_fma_f32 v[94:95], v[94:95], v[18:19], v[20:21] op_sel_hi:[1,0,0] neg_lo:[0,0,1] neg_hi:[0,0,1]
    v_pk_fma_f32 v[88:89], v[88:89], v[24:25], v[26:27]
    v_pk_fma_f32 v[90:91], v[90:91], v[28:29], v[30:31]
    v_pk_fma_f32 v[92:93], v[92:93], v[32:33], v[34:35]
    v_pk_fma_f32 v[94:95], v[94:95], v[36:37], v[38:39]
    v_cvt_pk_bf16_f32 v56, v88, v89
    v_cvt_pk_bf16_f32 v57, v90, v91
    v_cvt_pk_bf16_f32 v58, v92, v93
    v_cvt_pk_bf16_f32 v59, v94, v95
    ds_write_b128 v7, v[56:59] offset:0
    buffer_load_dwordx4 a[140:143], v3, s[36:39], s78 offen offset:3072 sc1
    s_add_u32 s78, s78, 4096
    buffer_load_dwordx4 a[144:147], v3, s[36:39], s78 offen offset:0 sc1
    s_waitcnt lgkmcnt(5)
    ds_read_b128 v[24:27], v6 offset:192
    ds_read_b128 v[28:31], v6 offset:208
    ds_read_b128 v[32:35], v6 offset:224
    ds_read_b128 v[36:39], v6 offset:240
    v_pk_fma_f32 v[96:97], v[96:97], v[18:19], v[20:21] op_sel_hi:[1,0,0] neg_lo:[0,0,1] neg_hi:[0,0,1]
    v_pk_fma_f32 v[98:99], v[98:99], v[18:19], v[20:21] op_sel_hi:[1,0,0] neg_lo:[0,0,1] neg_hi:[0,0,1]
    v_pk_fma_f32 v[100:101], v[100:101], v[18:19], v[20:21] op_sel_hi:[1,0,0] neg_lo:[0,0,1] neg_hi:[0,0,1]
    v_pk_fma_f32 v[102:103], v[102:103], v[18:19], v[20:21] op_sel_hi:[1,0,0] neg_lo:[0,0,1] neg_hi:[0,0,1]
    v_pk_fma_f32 v[96:97], v[96:97], v[40:41], v[42:43]
    v_pk_fma_f32 v[98:99], v[98:99], v[44:45], v[46:47]
    v_pk_fma_f32 v[100:101], v[100:101], v[48:49], v[50:51]
    v_pk_fma_f32 v[102:103], v[102:103], v[52:53], v[54:55]
    v_cvt_pk_bf16_f32 v60, v96, v97
    v_cvt_pk_bf16_f32 v61, v98, v99
    v_cvt_pk_bf16_f32 v62, v100, v101
    v_cvt_pk_bf16_f32 v63, v102, v103
    ds_write_b128 v7, v[60:63] offset:512
    buffer_load_dwordx4 a[148:151], v3, s[36:39], s78 offen offset:1024 sc1
    buffer_load_dwordx4 a[152:155], v3, s[36:39], s78 offen offset:2048 sc1
    s_waitcnt lgkmcnt(6)
    ds_read_b128 v[40:43], v6 offset:256
    ds_read_b128 v[44:47], v6 offset:272
    ds_read_b128 v[48:51], v6 offset:288
    ds_read_b128 v[52:55], v6 offset:304
    v_pk_fma_f32 v[104:105], v[104:105], v[18:19], v[20:21] op_sel_hi:[1,0,0] neg_lo:[0,0,1] neg_hi:[0,0,1]
    v_pk_fma_f32 v[106:107], v[106:107], v[18:19], v[20:21] op_sel_hi:[1,0,0] neg_lo:[0,0,1] neg_hi:[0,0,1]
    v_pk_fma_f32 v[108:109], v[108:109], v[18:19], v[20:21] op_sel_hi:[1,0,0] neg_lo:[0,0,1] neg_hi:[0,0,1]
    v_pk_fma_f32 v[110:111], v[110:111], v[18:19], v[20:21] op_sel_hi:[1,0,0] neg_lo:[0,0,1] neg_hi:[0,0,1]
    v_pk_fma_f32 v[104:105], v[104:105], v[72:73], v[74:75]
    v_pk_fma_f32 v[106:107], v[106:107], v[76:77], v[78:79]
    v_pk_fma_f32 v[108:109], v[108:109], v[80:81], v[82:83]
    v_pk_fma_f32 v[110:111], v[110:111], v[84:85], v[86:87]
    v_cvt_pk_bf16_f32 v64, v104, v105
    v_cvt_pk_bf16_f32 v65, v106, v107
    v_cvt_pk_bf16_f32 v66, v108, v109
    v_cvt_pk_bf16_f32 v67, v110, v111
    ds_write_b128 v7, v[64:67] offset:2048
    buffer_load_dwordx4 a[156:159], v3, s[36:39], s78 offen offset:3072 sc1
    s_add_u32 s78, s78, 4096
    buffer_load_dwordx4 a[160:163], v3, s[36:39], s78 offen offset:0 sc1
    s_waitcnt lgkmcnt(6)
    ds_read_b128 v[72:75], v6 offset:320
    ds_read_b128 v[76:79], v6 offset:336
    ds_read_b128 v[80:83], v6 offset:352
    ds_read_b128 v[84:87], v6 offset:368
    v_pk_fma_f32 v[112:113], v[112:113], v[18:19], v[20:21] op_sel_hi:[1,0,0] neg_lo:[0,0,1] neg_hi:[0,0,1]
    v_pk_fma_f32 v[114:115], v[114:115], v[18:19], v[20:21] op_sel_hi:[1,0,0] neg_lo:[0,0,1] neg_hi:[0,0,1]
    v_pk_fma_f32 v[116:117], v[116:117], v[18:19], v[20:21] op_sel_hi:[1,0,0] neg_lo:[0,0,1] neg_hi:[0,0,1]
    v_pk_fma_f32 v[118:119], v[118:119], v[18:19], v[20:21] op_sel_hi:[1,0,0] neg_lo:[0,0,1] neg_hi:[0,0,1]
    v_pk_fma_f32 v[112:113], v[112:113], v[24:25], v[26:27]
    v_pk_fma_f32 v[114:115], v[114:115], v[28:29], v[30:31]
    v_pk_fma_f32 v[116:117], v[116:117], v[32:33], v[34:35]
    v_pk_fma_f32 v[118:119], v[118:119], v[36:37], v[38:39]
    v_cvt_pk_bf16_f32 v68, v112, v113
    v_cvt_pk_bf16_f32 v69, v114, v115
    v_cvt_pk_bf16_f32 v70, v116, v117
    v_cvt_pk_bf16_f32 v71, v118, v119
    ds_write_b128 v7, v[68:71] offset:2560
    buffer_load_dwordx4 a[164:167], v3, s[36:39], s78 offen offset:1024 sc1
    buffer_load_dwordx4 a[168:171], v3, s[36:39], s78 offen offset:2048 sc1
    s_waitcnt lgkmcnt(6)
    ds_read_b128 v[24:27], v6 offset:384
    ds_read_b128 v[28:31], v6 offset:400
    ds_read_b128 v[32:35], v6 offset:416
    ds_read_b128 v[36:39], v6 offset:432
    v_pk_fma_f32 v[120:121], v[120:121], v[18:19], v[20:21] op_sel_hi:[1,0,0] neg_lo:[0,0,1] neg_hi:[0,0,1]
    v_pk_fma_f32 v[122:123], v[122:123], v[18:19], v[20:21] op_sel_hi:[1,0,0] neg_lo:[0,0,1] neg_hi:[0,0,1]
    v_pk_fma_f32 v[124:125], v[124:125], v[18:19], v[20:21] op_sel_hi:[1,0,0] neg_lo:[0,0,1] neg_hi:[0,0,1]
    v_pk_fma_f32 v[126:127], v[126:127], v[18:19], v[20:21] op_sel_hi:[1,0,0] neg_lo:[0,0,1] neg_hi:[0,0,1]
    v_pk_fma_f32 v[120:121], v[120:121], v[40:41], v[42:43]
    v_pk_fma_f32 v[122:123], v[122:123], v[44:45], v[46:47]
    v_pk_fma_f32 v[124:125], v[124:125], v[48:49], v[50:51]
    v_pk_fma_f32 v[126:127], v[126:127], v[52:53], v[54:55]
    v_cvt_pk_bf16_f32 v56, v120, v121
    v_cvt_pk_bf16_f32 v57, v122, v123
    v_cvt_pk_bf16_f32 v58, v124, v125
    v_cvt_pk_bf16_f32 v59, v126, v127
    ds_write_b128 v7, v[56:59] offset:4096
    buffer_load_dwordx4 a[172:175], v3, s[36:39], s78 offen offset:3072 sc1
    s_add_u32 s78, s78, 4096
    buffer_load_dwordx4 a[176:179], v3, s[36:39], s78 offen offset:0 sc1
    s_waitcnt lgkmcnt(6)
    ds_read_b128 v[40:43], v6 offset:448
    ds_read_b128 v[44:47], v6 offset:464
    ds_read_b128 v[48:51], v6 offset:480
    ds_read_b128 v[52:55], v6 offset:496
    v_pk_fma_f32 v[128:129], v[128:129], v[18:19], v[20:21] op_sel_hi:[1,0,0] neg_lo:[0,0,1] neg_hi:[0,0,1]
    v_pk_fma_f32 v[130:131], v[130:131], v[18:19], v[20:21] op_sel_hi:[1,0,0] neg_lo:[0,0,1] neg_hi:[0,0,1]
    v_pk_fma_f32 v[132:133], v[132:133], v[18:19], v[20:21] op_sel_hi:[1,0,0] neg_lo:[0,0,1] neg_hi:[0,0,1]
    v_pk_fma_f32 v[134:135], v[134:135], v[18:19], v[20:21] op_sel_hi:[1,0,0] neg_lo:[0,0,1] neg_hi:[0,0,1]
    v_pk_fma_f32 v[128:129], v[128:129], v[72:73], v[74:75]
    v_pk_fma_f32 v[130:131], v[130:131], v[76:77], v[78:79]
    v_pk_fma_f32 v[132:133], v[132:133], v[80:81], v[82:83]
    v_pk_fma_f32 v[134:135], v[134:135], v[84:85], v[86:87]
    v_cvt_pk_bf16_f32 v60, v128, v129
    v_cvt_pk_bf16_f32 v61, v130, v131
    v_cvt_pk_bf16_f32 v62, v132, v133
    v_cvt_pk_bf16_f32 v63, v134, v135
    ds_write_b128 v7, v[60:63] offset:4608
    buffer_load_dwordx4 a[180:183], v3, s[36:39], s78 offen offset:1024 sc1
    buffer_load_dwordx4 a[184:187], v3, s[36:39], s78 offen offset:2048 sc1
    s_waitcnt lgkmcnt(6)
    ds_read_b128 v[72:75], v6 offset:512
    ds_read_b128 v[76:79], v6 offset:528
    ds_read_b128 v[80:83], v6 offset:544
    ds_read_b128 v[84:87], v6 offset:560
    v_pk_fma_f32 v[136:137], v[136:137], v[18:19], v[20:21] op_sel_hi:[1,0,0] neg_lo:[0,0,1] neg_hi:[0,0,1]
    v_pk_fma_f32 v[138:139], v[138:139], v[18:19], v[20:21] op_sel_hi:[1,0,0] neg_lo:[0,0,1] neg_hi:[0,0,1]
    v_pk_fma_f32 v[140:141], v[140:141], v[18:19], v[20:21] op_sel_hi:[1,0,0] neg_lo:[0,0,1] neg_hi:[0,0,1]
    v_pk_fma_f32 v[142:143], v[142:143], v[18:19], v[20:21] op_sel_hi:[1,0,0] neg_lo:[0,0,1] neg_hi:[0,0,1]
    v_pk_fma_f32 v[136:137], v[136:137], v[24:25], v[26:27]
    v_pk_fma_f32 v[138:139], v[138:139], v[28:29], v[30:31]
    v_pk_fma_f32 v[140:141], v[140:141], v[32:33], v[34:35]
    v_pk_fma_f32 v[142:143], v[142:143], v[36:37], v[38:39]
    v_cvt_pk_bf16_f32 v64, v136, v137
    v_cvt_pk_bf16_f32 v65, v138, v139
    v_cvt_pk_bf16_f32 v66, v140, v141
    v_cvt_pk_bf16_f32 v67, v142, v143
    ds_write_b128 v7, v[64:67] offset:6144
    buffer_load_dwordx4 a[188:191], v3, s[36:39], s78 offen offset:3072 sc1
    s_add_u32 s78, s78, 4096
    buffer_load_dwordx4 a[192:195], v3, s[36:39], s78 offen offset:0 sc1
    s_waitcnt lgkmcnt(6)
    ds_read_b128 v[24:27], v6 offset:576
    ds_read_b128 v[28:31], v6 offset:592
    ds_read_b128 v[32:35], v6 offset:608
    ds_read_b128 v[36:39], v6 offset:624
    v_pk_fma_f32 v[144:145], v[144:145], v[18:19], v[20:21] op_sel_hi:[1,0,0] neg_lo:[0,0,1] neg_hi:[0,0,1]
    v_pk_fma_f32 v[146:147], v[146:147], v[18:19], v[20:21] op_sel_hi:[1,0,0] neg_lo:[0,0,1] neg_hi:[0,0,1]
    v_pk_fma_f32 v[148:149], v[148:149], v[18:19], v[20:21] op_sel_hi:[1,0,0] neg_lo:[0,0,1] neg_hi:[0,0,1]
    v_pk_fma_f32 v[150:151], v[150:151], v[18:19], v[20:21] op_sel_hi:[1,0,0] neg_lo:[0,0,1] neg_hi:[0,0,1]
    v_pk_fma_f32 v[144:145], v[144:145], v[40:41], v[42:43]
    v_pk_fma_f32 v[146:147], v[146:147], v[44:45], v[46:47]
    v_pk_fma_f32 v[148:149], v[148:149], v[48:49], v[50:51]
    v_pk_fma_f32 v[150:151], v[150:151], v[52:53], v[54:55]
    v_cvt_pk_bf16_f32 v68, v144, v145
    v_cvt_pk_bf16_f32 v69, v146, v147
    v_cvt_pk_bf16_f32 v70, v148, v149
    v_cvt_pk_bf16_f32 v71, v150, v151
    ds_write_b128 v7, v[68:71] offset:6656
    buffer_load_dwordx4 a[196:199], v3, s[36:39], s78 offen offset:1024 sc1
    buffer_load_dwordx4 a[200:203], v3, s[36:39], s78 offen offset:2048 sc1
    s_waitcnt lgkmcnt(6)
    ds_read_b128 v[40:43], v6 offset:640
    ds_read_b128 v[44:47], v6 offset:656
    ds_read_b128 v[48:51], v6 offset:672
    ds_read_b128 v[52:55], v6 offset:688
    v_pk_fma_f32 v[152:153], v[152:153], v[18:19], v[20:21] op_sel_hi:[1,0,0] neg_lo:[0,0,1] neg_hi:[0,0,1]
    v_pk_fma_f32 v[154:155], v[154:155], v[18:19], v[20:21] op_sel_hi:[1,0,0] neg_lo:[0,0,1] neg_hi:[0,0,1]
    v_pk_fma_f32 v[156:157], v[156:157], v[18:19], v[20:21] op_sel_hi:[1,0,0] neg_lo:[0,0,1] neg_hi:[0,0,1]
    v_pk_fma_f32 v[158:159], v[158:159], v[18:19], v[20:21] op_sel_hi:[1,0,0] neg_lo:[0,0,1] neg_hi:[0,0,1]
    v_pk_fma_f32 v[152:153], v[152:153], v[72:73], v[74:75]
    v_pk_fma_f32 v[154:155], v[154:155], v[76:77], v[78:79]
    v_pk_fma_f32 v[156:157], v[156:157], v[80:81], v[82:83]
    v_pk_fma_f32 v[158:159], v[158:159], v[84:85], v[86:87]
    v_cvt_pk_bf16_f32 v56, v152, v153
    v_cvt_pk_bf16_f32 v57, v154, v155
    v_cvt_pk_bf16_f32 v58, v156, v157
    v_cvt_pk_bf16_f32 v59, v158, v159
    ds_write_b128 v7, v[56:59] offset:8192
    buffer_load_dwordx4 a[204:207], v3, s[36:39], s78 offen offset:3072 sc1
    s_add_u32 s78, s78, 4096
    buffer_load_dwordx4 a[208:211], v3, s[36:39], s78 offen offset:0 sc1
    s_waitcnt lgkmcnt(6)
    ds_read_b128 v[72:75], v6 offset:704
    ds_read_b128 v[76:79], v6 offset:720
    ds_read_b128 v[80:83], v6 offset:736
    ds_read_b128 v[84:87], v6 offset:752
    v_pk_fma_f32 v[160:161], v[160:161], v[18:19], v[20:21] op_sel_hi:[1,0,0] neg_lo:[0,0,1] neg_hi:[0,0,1]
    v_pk_fma_f32 v[162:163], v[162:163], v[18:19], v[20:21] op_sel_hi:[1,0,0] neg_lo:[0,0,1] neg_hi:[0,0,1]
    v_pk_fma_f32 v[164:165], v[164:165], v[18:19], v[20:21] op_sel_hi:[1,0,0] neg_lo:[0,0,1] neg_hi:[0,0,1]
    v_pk_fma_f32 v[166:167], v[166:167], v[18:19], v[20:21] op_sel_hi:[1,0,0] neg_lo:[0,0,1] neg_hi:[0,0,1]
    v_pk_fma_f32 v[160:161], v[160:161], v[24:25], v[26:27]
    v_pk_fma_f32 v[162:163], v[162:163], v[28:29], v[30:31]
    v_pk_fma_f32 v[164:165], v[164:165], v[32:33], v[34:35]
    v_pk_fma_f32 v[166:167], v[166:167], v[36:37], v[38:39]
    v_cvt_pk_bf16_f32 v60, v160, v161
    v_cvt_pk_bf16_f32 v61, v162, v163
    v_cvt_pk_bf16_f32 v62, v164, v165
    v_cvt_pk_bf16_f32 v63, v166, v167
    ds_write_b128 v7, v[60:63] offset:8704
    buffer_load_dwordx4 a[212:215], v3, s[36:39], s78 offen offset:1024 sc1
    buffer_load_dwordx4 a[216:219], v3, s[36:39], s78 offen offset:2048 sc1
    s_waitcnt lgkmcnt(6)
    ds_read_b128 v[24:27], v6 offset:768
    ds_read_b128 v[28:31], v6 offset:784
    ds_read_b128 v[32:35], v6 offset:800
    ds_read_b128 v[36:39], v6 offset:816
    v_pk_fma_f32 v[168:169], v[168:169], v[18:19], v[20:21] op_sel_hi:[1,0,0] neg_lo:[0,0,1] neg_hi:[0,0,1]
    v_pk_fma_f32 v[170:171], v[170:171], v[18:19], v[20:21] op_sel_hi:[1,0,0] neg_lo:[0,0,1] neg_hi:[0,0,1]
    v_pk_fma_f32 v[172:173], v[172:173], v[18:19], v[20:21] op_sel_hi:[1,0,0] neg_lo:[0,0,1] neg_hi:[0,0,1]
    v_pk_fma_f32 v[174:175], v[174:175], v[18:19], v[20:21] op_sel_hi:[1,0,0] neg_lo:[0,0,1] neg_hi:[0,0,1]
    v_pk_fma_f32 v[168:169], v[168:169], v[40:41], v[42:43]
    v_pk_fma_f32 v[170:171], v[170:171], v[44:45], v[46:47]
    v_pk_fma_f32 v[172:173], v[172:173], v[48:49], v[50:51]
    v_pk_fma_f32 v[174:175], v[174:175], v[52:53], v[54:55]
    v_cvt_pk_bf16_f32 v64, v168, v169
    v_cvt_pk_bf16_f32 v65, v170, v171
    v_cvt_pk_bf16_f32 v66, v172, v173
    v_cvt_pk_bf16_f32 v67, v174, v175
    ds_write_b128 v7, v[64:67] offset:10240
    buffer_load_dwordx4 a[220:223], v3, s[36:39], s78 offen offset:3072 sc1
    s_add_u32 s79, s79, 40960
    buffer_load_dwordx4 a[224:227], v253, s[36:39], s79 offen offset:0 sc1
    s_waitcnt lgkmcnt(6)
    ds_read_b128 v[40:43], v6 offset:832
    ds_read_b128 v[44:47], v6 offset:848
    ds_read_b128 v[48:51], v6 offset:864
    ds_read_b128 v[52:55], v6 offset:880
    v_pk_fma_f32 v[176:177], v[176:177], v[18:19], v[20:21] op_sel_hi:[1,0,0] neg_lo:[0,0,1] neg_hi:[0,0,1]
    v_pk_fma_f32 v[178:179], v[178:179], v[18:19], v[20:21] op_sel_hi:[1,0,0] neg_lo:[0,0,1] neg_hi:[0,0,1]
    v_pk_fma_f32 v[180:181], v[180:181], v[18:19], v[20:21] op_sel_hi:[1,0,0] neg_lo:[0,0,1] neg_hi:[0,0,1]
    v_pk_fma_f32 v[182:183], v[182:183], v[18:19], v[20:21] op_sel_hi:[1,0,0] neg_lo:[0,0,1] neg_hi:[0,0,1]
    v_pk_fma_f32 v[176:177], v[176:177], v[72:73], v[74:75]
    v_pk_fma_f32 v[178:179], v[178:179], v[76:77], v[78:79]
    v_pk_fma_f32 v[180:181], v[180:181], v[80:81], v[82:83]
    v_pk_fma_f32 v[182:183], v[182:183], v[84:85], v[86:87]
    v_cvt_pk_bf16_f32 v68, v176, v177
    v_cvt_pk_bf16_f32 v69, v178, v179
    v_cvt_pk_bf16_f32 v70, v180, v181
    v_cvt_pk_bf16_f32 v71, v182, v183
    ds_write_b128 v7, v[68:71] offset:10752
    buffer_load_dwordx4 a[228:231], v2, s[36:39], s79 offen offset:2048 sc1
    buffer_load_dwordx4 a[232:235], v253, s[36:39], s79 offen offset:2048 sc1
    s_waitcnt lgkmcnt(6)
    v_pk_fma_f32 v[184:185], v[184:185], v[18:19], v[20:21] op_sel_hi:[1,0,0] neg_lo:[0,0,1] neg_hi:[0,0,1]
    v_pk_fma_f32 v[186:187], v[186:187], v[18:19], v[20:21] op_sel_hi:[1,0,0] neg_lo:[0,0,1] neg_hi:[0,0,1]
    v_pk_fma_f32 v[188:189], v[188:189], v[18:19], v[20:21] op_sel_hi:[1,0,0] neg_lo:[0,0,1] neg_hi:[0,0,1]
    v_pk_fma_f32 v[190:191], v[190:191], v[18:19], v[20:21] op_sel_hi:[1,0,0] neg_lo:[0,0,1] neg_hi:[0,0,1]
    v_pk_fma_f32 v[184:185], v[184:185], v[24:25], v[26:27]
    v_pk_fma_f32 v[186:187], v[186:187], v[28:29], v[30:31]
    v_pk_fma_f32 v[188:189], v[188:189], v[32:33], v[34:35]
    v_pk_fma_f32 v[190:191], v[190:191], v[36:37], v[38:39]
    v_cvt_pk_bf16_f32 v56, v184, v185
    v_cvt_pk_bf16_f32 v57, v186, v187
    v_cvt_pk_bf16_f32 v58, v188, v189
    v_cvt_pk_bf16_f32 v59, v190, v191
    ds_write_b128 v7, v[56:59] offset:12288
    s_add_u32 s79, s79, 4096
    buffer_load_dwordx4 a[236:239], v2, s[36:39], s79 offen offset:0 sc1
    buffer_load_dwordx4 a[240:243], v253, s[36:39], s79 offen offset:0 sc1
    s_waitcnt lgkmcnt(2)
    v_pk_fma_f32 v[192:193], v[192:193], v[18:19], v[20:21] op_sel_hi:[1,0,0] neg_lo:[0,0,1] neg_hi:[0,0,1]
    v_pk_fma_f32 v[194:195], v[194:195], v[18:19], v[20:21] op_sel_hi:[1,0,0] neg_lo:[0,0,1] neg_hi:[0,0,1]
    v_pk_fma_f32 v[196:197], v[196:197], v[18:19], v[20:21] op_sel_hi:[1,0,0] neg_lo:[0,0,1] neg_hi:[0,0,1]
    v_pk_fma_f32 v[198:199], v[198:199], v[18:19], v[20:21] op_sel_hi:[1,0,0] neg_lo:[0,0,1] neg_hi:[0,0,1]
    v_pk_fma_f32 v[192:193], v[192:193], v[40:41], v[42:43]
    v_pk_fma_f32 v[194:195], v[194:195], v[44:45], v[46:47]
    v_pk_fma_f32 v[196:197], v[196:197], v[48:49], v[50:51]
    v_pk_fma_f32 v[198:199], v[198:199], v[52:53], v[54:55]
    v_cvt_pk_bf16_f32 v60, v192, v193
    v_cvt_pk_bf16_f32 v61, v194, v195
    v_cvt_pk_bf16_f32 v62, v196, v197
    v_cvt_pk_bf16_f32 v63, v198, v199
    ds_write_b128 v7, v[60:63] offset:12800
    buffer_load_dwordx4 a[244:247], v2, s[36:39], s79 offen offset:2048 sc1
    buffer_load_dwordx4 a[248:251], v253, s[36:39], s79 offen offset:2048 sc1
    s_add_u32 s79, s79, 4096
    buffer_load_dwordx4 a[252:255], v2, s[36:39], s79 offen offset:0 sc1
    s_waitcnt lgkmcnt(0)
    s_barrier
    s_mul_i32 s57, s4, 112
    s_lshl_b32 s58, s5, 4
    s_add_u32 s57, s57, s58
    s_lshl_b32 s58, s6, 2
    s_add_u32 s57, s57, s58
    s_lshl_b32 s89, s57, 11
    s_add_u32 s89, s89, 9060352
    s_add_u32 s91, s89, 4096
    s_mov_b32 s90, 0x3fb8aa3b
    ds_read_b128 v[4:7], v3 offset:0
    ds_read_b128 v[8:11], v3 offset:2048
    ds_read_b128 v[12:15], v3 offset:4096
    ds_read_b128 v[16:19], v3 offset:6144
    s_waitcnt lgkmcnt(2)
    v_mfma_f32_32x32x16_bf16 v[24:39], a[0:3], v[4:7], 0
    ds_read_b128 v[20:23], v3 offset:8192
    ds_read_b128 v[56:59], v3 offset:10240
    v_mfma_f32_32x32x16_bf16 v[24:39], a[4:7], v[8:11], v[24:39]
    s_waitcnt lgkmcnt(2)
    v_mfma_f32_32x32x16_bf16 v[24:39], a[8:11], v[12:15], v[24:39]
    ds_read_b128 v[4:7], v3 offset:12288
    ds_read_b128 v[8:11], v3 offset:14336
    v_mfma_f32_32x32x16_bf16 v[24:39], a[12:15], v[16:19], v[24:39]
    s_sub_u32 s79, s79, 20480
    buffer_load_dwordx4 v[200:203], v2, s[36:39], s79 offen offset:0 sc1
    s_waitcnt lgkmcnt(2)
    v_mfma_f32_32x32x16_bf16 v[24:39], a[16:19], v[20:23], v[24:39]
    ds_read_b128 v[12:15], v3 offset:16384
    ds_read_b128 v[16:19], v3 offset:18432
    v_mfma_f32_32x32x16_bf16 v[24:39], a[20:23], v[56:59], v[24:39]
    buffer_load_dwordx4 v[204:207], v253, s[36:39], s79 offen offset:0 sc1
    s_waitcnt lgkmcnt(2)
    v_mfma_f32_32x32x16_bf16 v[24:39], a[24:27], v[4:7], v[24:39]
    ds_read_b128 v[20:23], v3 offset:20480
    ds_read_b128 v[56:59], v3 offset:22528
    v_mfma_f32_32x32x16_bf16 v[24:39], a[28:31], v[8:11], v[24:39]
    s_waitcnt lgkmcnt(2)
    v_mfma_f32_32x32x16_bf16 v[24:39], a[32:35], v[12:15], v[24:39]
    ds_read_b128 v[4:7], v3 offset:24576
    ds_read_b128 v[8:11], v3 offset:26624
    v_mfma_f32_32x32x16_bf16 v[24:39], a[36:39], v[16:19], v[24:39]
    buffer_load_dwordx4 v[208:211], v2, s[36:39], s79 offen offset:2048 sc1
    s_waitcnt lgkmcnt(2)
    v_mfma_f32_32x32x16_bf16 v[24:39], a[40:43], v[20:23], v[24:39]
    ds_read_b128 v[12:15], v3 offset:28672
    ds_read_b128 v[16:19], v3 offset:30720
    v_mfma_f32_32x32x16_bf16 v[24:39], a[44:47], v[56:59], v[24:39]
    buffer_load_dwordx4 v[212:215], v253, s[36:39], s79 offen offset:2048 sc1
    s_waitcnt lgkmcnt(2)
    v_mfma_f32_32x32x16_bf16 v[24:39], a[48:51], v[4:7], v[24:39]
    ds_read_b128 v[20:23], v3 offset:32768
    ds_read_b128 v[56:59], v3 offset:34816
    v_mfma_f32_32x32x16_bf16 v[24:39], a[52:55], v[8:11], v[24:39]
    s_waitcnt lgkmcnt(2)
    v_mfma_f32_32x32x16_bf16 v[24:39], a[56:59], v[12:15], v[24:39]
    ds_read_b128 v[4:7], v3 offset:36864
    ds_read_b128 v[8:11], v3 offset:38912
    v_mfma_f32_32x32x16_bf16 v[24:39], a[60:63], v[16:19], v[24:39]
    s_add_u32 s79, s79, 4096
    buffer_load_dwordx4 v[216:219], v2, s[36:39], s79 offen offset:0 sc1
    s_waitcnt lgkmcnt(2)
    v_mfma_f32_32x32x16_bf16 v[24:39], a[64:67], v[20:23], v[24:39]
    ds_read_b128 v[12:15], v3 offset:40960
    ds_read_b128 v[16:19], v3 offset:43008
    v_mfma_f32_32x32x16_bf16 v[24:39], a[68:71], v[56:59], v[24:39]
    buffer_load_dwordx4 v[220:223], v253, s[36:39], s79 offen offset:0 sc1
    s_waitcnt lgkmcnt(2)
    v_mfma_f32_32x32x16_bf16 v[24:39], a[72:75], v[4:7], v[24:39]
    ds_read_b128 v[20:23], v3 offset:45056
    ds_read_b128 v[56:59], v3 offset:47104
    v_mfma_f32_32x32x16_bf16 v[24:39], a[76:79], v[8:11], v[24:39]
    s_waitcnt lgkmcnt(2)
    v_mfma_f32_32x32x16_bf16 v[24:39], a[80:83], v[12:15], v[24:39]
    ds_read_b128 v[4:7], v3 offset:49152
    ds_read_b128 v[8:11], v3 offset:51200
    v_mfma_f32_32x32x16_bf16 v[24:39], a[84:87], v[16:19], v[24:39]
    buffer_load_dwordx4 v[224:227], v2, s[36:39], s79 offen offset:2048 sc1
    s_waitcnt lgkmcnt(2)
    v_mfma_f32_32x32x16_bf16 v[24:39], a[88:91], v[20:23], v[24:39]
    ds_read_b128 v[12:15], v3 offset:53248
    ds_read_b128 v[16:19], v3 offset:55296
    v_mfma_f32_32x32x16_bf16 v[24:39], a[92:95], v[56:59], v[24:39]
    buffer_load_dwordx4 v[228:231], v253, s[36:39], s79 offen offset:2048 sc1
    s_waitcnt lgkmcnt(2)
    s_waitcnt vmcnt(47)
    v_mfma_f32_32x32x16_bf16 v[24:39], a[96:99], v[4:7], v[24:39]
    ds_read_b128 v[20:23], v3 offset:1024
    ds_read_b128 v[56:59], v3 offset:3072
    s_waitcnt vmcnt(46)
    v_mfma_f32_32x32x16_bf16 v[24:39], a[100:103], v[8:11], v[24:39]
    s_waitcnt lgkmcnt(2)
    s_waitcnt vmcnt(45)
    v_mfma_f32_32x32x16_bf16 v[24:39], a[104:107], v[12:15], v[24:39]
    ds_read_b128 v[4:7], v3 offset:5120
    ds_read_b128 v[8:11], v3 offset:7168
    s_waitcnt vmcnt(44)
    v_mfma_f32_32x32x16_bf16 v[24:39], a[108:111], v[16:19], v[24:39]
    s_add_u32 s79, s79, 4096
    buffer_load_dwordx4 v[232:235], v2, s[36:39], s79 offen offset:0 sc1
    s_waitcnt lgkmcnt(2)
    v_mfma_f32_32x32x16_bf16 v[40:55], a[0:3], v[20:23], 0
    ds_read_b128 v[12:15], v3 offset:9216
    ds_read_b128 v[16:19], v3 offset:11264
    v_mfma_f32_32x32x16_bf16 v[40:55], a[4:7], v[56:59], v[40:55]
    buffer_load_dwordx4 v[236:239], v253, s[36:39], s79 offen offset:0 sc1
    s_waitcnt lgkmcnt(2)
    v_mfma_f32_32x32x16_bf16 v[40:55], a[8:11], v[4:7], v[40:55]
    ds_read_b128 v[20:23], v3 offset:13312
    ds_read_b128 v[56:59], v3 offset:15360
    v_exp_f32 v68, -v24
    v_exp_f32 v69, -v25
    v_mfma_f32_32x32x16_bf16 v[40:55], a[12:15], v[8:11], v[40:55]
    v_exp_f32 v70, -v26
    v_fma_f32 v68, v68, s90, s90
    v_exp_f32 v71, -v27
    s_waitcnt lgkmcnt(2)
    v_mfma_f32_32x32x16_bf16 v[40:55], a[16:19], v[12:15], v[40:55]
    ds_read_b128 v[4:7], v3 offset:17408
    ds_read_b128 v[8:11], v3 offset:19456
    v_fma_f32 v69, v69, s90, s90
    v_rcp_f32 v68, v68
    v_mfma_f32_32x32x16_bf16 v[40:55], a[20:23], v[16:19], v[40:55]
    buffer_load_dwordx4 v[240:243], v2, s[36:39], s79 offen offset:2048 sc1
    v_exp_f32 v72, -v28
    v_fma_f32 v70, v70, s90, s90
    s_waitcnt lgkmcnt(2)
    v_mfma_f32_32x32x16_bf16 v[40:55], a[24:27], v[20:23], v[40:55]
    ds_read_b128 v[12:15], v3 offset:21504
    ds_read_b128 v[16:19], v3 offset:23552
    v_rcp_f32 v69, v69
    v_exp_f32 v73, -v29
    v_mfma_f32_32x32x16_bf16 v[40:55], a[28:31], v[56:59], v[40:55]
    buffer_load_dwordx4 v[244:247], v253, s[36:39], s79 offen offset:2048 sc1
    v_fma_f32 v71, v71, s90, s90
    v_rcp_f32 v70, v70
    v_mul_f32 v24, v24, v68
    s_waitcnt lgkmcnt(2)
    v_mfma_f32_32x32x16_bf16 v[40:55], a[32:35], v[4:7], v[40:55]
    ds_read_b128 v[20:23], v3 offset:25600
    ds_read_b128 v[56:59], v3 offset:27648
    v_exp_f32 v74, -v30
    v_fma_f32 v72, v72, s90, s90
    v_mfma_f32_32x32x16_bf16 v[40:55], a[36:39], v[8:11], v[40:55]
    v_rcp_f32 v71, v71
    v_mul_f32 v25, v25, v69
    v_exp_f32 v75, -v31
    s_waitcnt lgkmcnt(2)
    v_mfma_f32_32x32x16_bf16 v[40:55], a[40:43], v[12:15], v[40:55]
    ds_read_b128 v[4:7], v3 offset:29696
    ds_read_b128 v[8:11], v3 offset:31744
    v_fma_f32 v73, v73, s90, s90
    v_rcp_f32 v72, v72
    v_mul_f32 v26, v26, v70
    v_mfma_f32_32x32x16_bf16 v[40:55], a[44:47], v[16:19], v[40:55]
    s_add_u32 s79, s79, 4096
    buffer_load_dwordx4 v[248:251], v2, s[36:39], s79 offen offset:0 sc1
    v_cvt_pk_bf16_f32 v76, v24, v25
    v_exp_f32 v68, -v32
    v_fma_f32 v74, v74, s90, s90
    s_waitcnt lgkmcnt(2)
    v_mfma_f32_32x32x16_bf16 v[40:55], a[48:51], v[20:23], v[40:55]
    ds_read_b128 v[12:15], v3 offset:33792
    ds_read_b128 v[16:19], v3 offset:35840
    v_rcp_f32 v73, v73
    v_mul_f32 v27, v27, v71
    v_mfma_f32_32x32x16_bf16 v[40:55], a[52:55], v[56:59], v[40:55]
    s_sub_u32 s79, s79, 40960
    buffer_load_dwordx4 v[88:91], v2, s[36:39], s79 offen offset:0 sc1
    v_exp_f32 v69, -v33
    v_fma_f32 v75, v75, s90, s90
    s_waitcnt lgkmcnt(2)
    v_mfma_f32_32x32x16_bf16 v[40:55], a[56:59], v[4:7], v[40:55]
    ds_read_b128 v[20:23], v3 offset:37888
    ds_read_b128 v[56:59], v3 offset:39936
    v_rcp_f32 v74, v74
    v_mul_f32 v28, v28, v72
    v_cvt_pk_bf16_f32 v77, v26, v27
    v_mfma_f32_32x32x16_bf16 v[40:55], a[60:63], v[8:11], v[40:55]
    v_exp_f32 v70, -v34
    v_fma_f32 v68, v68, s90, s90
    v_rcp_f32 v75, v75
    s_waitcnt lgkmcnt(2)
    v_mfma_f32_32x32x16_bf16 v[40:55], a[64:67], v[12:15], v[40:55]
    ds_read_b128 v[4:7], v3 offset:41984
    ds_read_b128 v[8:11], v3 offset:44032
    v_mul_f32 v29, v29, v73
    v_exp_f32 v71, -v35
    v_fma_f32 v69, v69, s90, s90
    v_mfma_f32_32x32x16_bf16 v[40:55], a[68:71], v[16:19], v[40:55]
    buffer_load_dwordx4 v[92:95], v253, s[36:39], s79 offen offset:0 sc1
    v_rcp_f32 v68, v68
    v_mul_f32 v30, v30, v74
    v_cvt_pk_bf16_f32 v78, v28, v29
    s_waitcnt lgkmcnt(2)
    v_mfma_f32_32x32x16_bf16 v[40:55], a[72:75], v[20:23], v[40:55]
    ds_read_b128 v[12:15], v3 offset:46080
    ds_read_b128 v[16:19], v3 offset:48128
    v_exp_f32 v72, -v36
    v_fma_f32 v70, v70, s90, s90
    v_mfma_f32_32x32x16_bf16 v[40:55], a[76:79], v[56:59], v[40:55]
    buffer_load_dwordx4 v[96:99], v2, s[36:39], s79 offen offset:2048 sc1
    v_rcp_f32 v69, v69
    v_mul_f32 v31, v31, v75
    s_waitcnt lgkmcnt(2)
    v_mfma_f32_32x32x16_bf16 v[40:55], a[80:83], v[4:7], v[40:55]
    ds_read_b128 v[20:23], v3 offset:50176
    ds_read_b128 v[56:59], v3 offset:52224
    v_exp_f32 v73, -v37
    v_fma_f32 v71, v71, s90, s90
    v_mfma_f32_32x32x16_bf16 v[40:55], a[84:87], v[8:11], v[40:55]
    v_rcp_f32 v70, v70
    v_mul_f32 v32, v32, v68
    v_cvt_pk_bf16_f32 v79, v30, v31
    buffer_store_dwordx4 v[76:79], v3, s[36:39], s89 offen offset:0 sc1
    s_waitcnt lgkmcnt(2)
    v_mfma_f32_32x32x16_bf16 v[40:55], a[88:91], v[12:15], v[40:55]
    ds_read_b128 v[4:7], v3 offset:54272
    ds_read_b128 v[8:11], v3 offset:56320
    v_exp_f32 v74, -v38
    v_fma_f32 v72, v72, s90, s90
    v_rcp_f32 v71, v71
    v_mfma_f32_32x32x16_bf16 v[40:55], a[92:95], v[16:19], v[40:55]
    buffer_load_dwordx4 v[100:103], v253, s[36:39], s79 offen offset:2048 sc1
    v_mul_f32 v33, v33, v69
    v_exp_f32 v75, -v39
    v_fma_f32 v73, v73, s90, s90
    v_rcp_f32 v72, v72
    s_waitcnt lgkmcnt(2)
    v_mfma_f32_32x32x16_bf16 v[40:55], a[96:99], v[20:23], v[40:55]
    ds_read_b128 v[12:15], v3 offset:0
    ds_read_b128 v[16:19], v3 offset:2048
    v_mul_f32 v34, v34, v70
    v_cvt_pk_bf16_f32 v80, v32, v33
    v_fma_f32 v74, v74, s90, s90
    v_rcp_f32 v73, v73
    v_mfma_f32_32x32x16_bf16 v[40:55], a[100:103], v[56:59], v[40:55]
    s_add_u32 s79, s79, 4096
    buffer_load_dwordx4 v[104:107], v2, s[36:39], s79 offen offset:0 sc1
    v_mul_f32 v35, v35, v71
    v_fma_f32 v75, v75, s90, s90
    v_rcp_f32 v74, v74
    s_waitcnt lgkmcnt(2)
    v_mfma_f32_32x32x16_bf16 v[40:55], a[104:107], v[4:7], v[40:55]
    ds_read_b128 v[20:23], v3 offset:4096
    ds_read_b128 v[56:59], v3 offset:6144
    v_mul_f32 v36, v36, v72
    v_cvt_pk_bf16_f32 v81, v34, v35
    v_rcp_f32 v75, v75
    v_mul_f32 v37, v37, v73
    v_mfma_f32_32x32x16_bf16 v[40:55], a[108:111], v[8:11], v[40:55]
    buffer_load_dwordx4 v[108:111], v253, s[36:39], s79 offen offset:0 sc1
    v_mul_f32 v38, v38, v74
    v_cvt_pk_bf16_f32 v82, v36, v37
    v_mul_f32 v39, v39, v75
    v_cvt_pk_bf16_f32 v83, v38, v39
    buffer_store_dwordx4 v[80:83], v3, s[36:39], s89 offen offset:2048 sc1
    s_waitcnt lgkmcnt(2)
    s_waitcnt vmcnt(56)
    v_mfma_f32_32x32x16_bf16 v[24:39], a[112:115], v[12:15], 0
    ds_read_b128 v[4:7], v3 offset:8192
    ds_read_b128 v[8:11], v3 offset:10240
    s_waitcnt vmcnt(55)
    v_mfma_f32_32x32x16_bf16 v[24:39], a[116:119], v[16:19], v[24:39]
    s_waitcnt lgkmcnt(2)
    s_waitcnt vmcnt(54)
    v_mfma_f32_32x32x16_bf16 v[24:39], a[120:123], v[20:23], v[24:39]
    ds_read_b128 v[12:15], v3 offset:12288
    ds_read_b128 v[16:19], v3 offset:14336
    v_exp_f32 v68, -v40
    v_exp_f32 v69, -v41
    s_waitcnt vmcnt(53)
    v_mfma_f32_32x32x16_bf16 v[24:39], a[124:127], v[56:59], v[24:39]
    buffer_load_dwordx4 v[112:115], v2, s[36:39], s79 offen offset:2048 sc1
    v_exp_f32 v70, -v42
    v_fma_f32 v68, v68, s90, s90
    s_waitcnt lgkmcnt(2)
    s_waitcnt vmcnt(53)
    v_mfma_f32_32x32x16_bf16 v[24:39], a[128:131], v[4:7], v[24:39]
    ds_read_b128 v[20:23], v3 offset:16384
    ds_read_b128 v[56:59], v3 offset:18432
    v_exp_f32 v71, -v43
    v_fma_f32 v69, v69, s90, s90
    s_waitcnt vmcnt(52)
    v_mfma_f32_32x32x16_bf16 v[24:39], a[132:135], v[8:11], v[24:39]
    buffer_load_dwordx4 v[116:119], v253, s[36:39], s79 offen offset:2048 sc1
    v_rcp_f32 v68, v68
    v_exp_f32 v72, -v44
    s_waitcnt lgkmcnt(2)
    s_waitcnt vmcnt(52)
    v_mfma_f32_32x32x16_bf16 v[24:39], a[136:139], v[12:15], v[24:39]
    ds_read_b128 v[4:7], v3 offset:20480
    ds_read_b128 v[8:11], v3 offset:22528
    v_fma_f32 v70, v70, s90, s90
    v_rcp_f32 v69, v69
    s_waitcnt vmcnt(51)
    v_mfma_f32_32x32x16_bf16 v[24:39], a[140:143], v[16:19], v[24:39]
    v_exp_f32 v73, -v45
    v_fma_f32 v71, v71, s90, s90
    v_rcp_f32 v70, v70
    s_waitcnt lgkmcnt(2)
    s_waitcnt vmcnt(50)
    v_mfma_f32_32x32x16_bf16 v[24:39], a[144:147], v[20:23], v[24:39]
    ds_read_b128 v[12:15], v3 offset:24576
    ds_read_b128 v[16:19], v3 offset:26624
    v_mul_f32 v40, v40, v68
    v_exp_f32 v74, -v46
    v_fma_f32 v72, v72, s90, s90
    s_waitcnt vmcnt(49)
    v_mfma_f32_32x32x16_bf16 v[24:39], a[148:151], v[56:59], v[24:39]
    s_add_u32 s79, s79, 4096
    buffer_load_dwordx4 v[120:123], v2, s[36:39], s79 offen offset:0 sc1
    v_rcp_f32 v71, v71
    v_mul_f32 v41, v41, v69
    s_waitcnt lgkmcnt(2)
    s_waitcnt vmcnt(49)
    v_mfma_f32_32x32x16_bf16 v[24:39], a[152:155], v[4:7], v[24:39]
    ds_read_b128 v[20:23], v3 offset:28672
    ds_read_b128 v[56:59], v3 offset:30720
    v_exp_f32 v75, -v47
    v_fma_f32 v73, v73, s90, s90
    s_waitcnt vmcnt(48)
    v_mfma_f32_32x32x16_bf16 v[24:39], a[156:159], v[8:11], v[24:39]
    buffer_load_dwordx4 v[124:127], v253, s[36:39], s79 offen offset:0 sc1
    v_rcp_f32 v72, v72
    v_mul_f32 v42, v42, v70
    v_cvt_pk_bf16_f32 v76, v40, v41
    s_waitcnt lgkmcnt(2)
    s_waitcnt vmcnt(48)
    v_mfma_f32_32x32x16_bf16 v[24:39], a[160:163], v[12:15], v[24:39]
    ds_read_b128 v[4:7], v3 offset:32768
    ds_read_b128 v[8:11], v3 offset:34816
    v_exp_f32 v68, -v48
    v_fma_f32 v74, v74, s90, s90
    s_waitcnt vmcnt(47)
    v_mfma_f32_32x32x16_bf16 v[24:39], a[164:167], v[16:19], v[24:39]
    v_rcp_f32 v73, v73
    v_mul_f32 v43, v43, v71
    v_exp_f32 v69, -v49
    s_waitcnt lgkmcnt(2)
    s_waitcnt vmcnt(46)
    v_mfma_f32_32x32x16_bf16 v[24:39], a[168:171], v[20:23], v[24:39]
    ds_read_b128 v[12:15], v3 offset:36864
    ds_read_b128 v[16:19], v3 offset:38912
    v_fma_f32 v75, v75, s90, s90
    v_rcp_f32 v74, v74
    v_mul_f32 v44, v44, v72
    s_waitcnt vmcnt(45)
    v_mfma_f32_32x32x16_bf16 v[24:39], a[172:175], v[56:59], v[24:39]
    buffer_load_dwordx4 v[128:131], v2, s[36:39], s79 offen offset:2048 sc1
    v_cvt_pk_bf16_f32 v77, v42, v43
    v_exp_f32 v70, -v50
    v_fma_f32 v68, v68, s90, s90
    s_waitcnt lgkmcnt(2)
    s_waitcnt vmcnt(45)
    v_mfma_f32_32x32x16_bf16 v[24:39], a[176:179], v[4:7], v[24:39]
    ds_read_b128 v[20:23], v3 offset:40960
    ds_read_b128 v[56:59], v3 offset:43008
    v_rcp_f32 v75, v75
    v_mul_f32 v45, v45, v73
    s_waitcnt vmcnt(44)
    v_mfma_f32_32x32x16_bf16 v[24:39], a[180:183], v[8:11], v[24:39]
    buffer_load_dwordx4 v[132:135], v253, s[36:39], s79 offen offset:2048 sc1
    v_exp_f32 v71, -v51
    v_fma_f32 v69, v69, s90, s90
    s_waitcnt lgkmcnt(2)
    s_waitcnt vmcnt(44)
    v_mfma_f32_32x32x16_bf16 v[24:39], a[184:187], v[12:15], v[24:39]
    ds_read_b128 v[4:7], v3 offset:45056
    ds_read_b128 v[8:11], v3 offset:47104
    v_rcp_f32 v68, v68
    v_mul_f32 v46, v46, v74
    v_cvt_pk_bf16_f32 v78, v44, v45
    s_waitcnt vmcnt(43)
    v_mfma_f32_32x32x16_bf16 v[24:39], a[188:191], v[16:19], v[24:39]
    v_exp_f32 v72, -v52
    v_fma_f32 v70, v70, s90, s90
    v_rcp_f32 v69, v69
    s_waitcnt lgkmcnt(2)
    s_waitcnt vmcnt(42)
    v_mfma_f32_32x32x16_bf16 v[24:39], a[192:195], v[20:23], v[24:39]
    ds_read_b128 v[12:15], v3 offset:49152
    ds_read_b128 v[16:19], v3 offset:51200
    v_mul_f32 v47, v47, v75
    v_exp_f32 v73, -v53
    v_fma_f32 v71, v71, s90, s90
    s_waitcnt vmcnt(41)
    v_mfma_f32_32x32x16_bf16 v[24:39], a[196:199], v[56:59], v[24:39]
    s_add_u32 s79, s79, 4096
    buffer_load_dwordx4 v[136:139], v2, s[36:39], s79 offen offset:0 sc1
    v_rcp_f32 v70, v70
    v_mul_f32 v48, v48, v68
    v_cvt_pk_bf16_f32 v79, v46, v47
    buffer_store_dwordx4 v[76:79], v3, s[36:39], s89 offen offset:1024 sc1
    s_waitcnt lgkmcnt(2)
    s_waitcnt vmcnt(42)
    v_mfma_f32_32x32x16_bf16 v[24:39], a[200:203], v[4:7], v[24:39]
    ds_read_b128 v[20:23], v3 offset:53248
    ds_read_b128 v[56:59], v3 offset:55296
    v_exp_f32 v74, -v54
    v_fma_f32 v72, v72, s90, s90
    v_rcp_f32 v71, v71
    s_waitcnt vmcnt(41)
    v_mfma_f32_32x32x16_bf16 v[24:39], a[204:207], v[8:11], v[24:39]
    buffer_load_dwordx4 v[140:143], v253, s[36:39], s79 offen offset:0 sc1
    v_mul_f32 v49, v49, v69
    v_exp_f32 v75, -v55
    v_fma_f32 v73, v73, s90, s90
    v_rcp_f32 v72, v72
    s_waitcnt lgkmcnt(2)
    s_waitcnt vmcnt(41)
    v_mfma_f32_32x32x16_bf16 v[24:39], a[208:211], v[12:15], v[24:39]
    ds_read_b128 v[4:7], v3 offset:1024
    ds_read_b128 v[8:11], v3 offset:3072
    v_mul_f32 v50, v50, v70
    v_cvt_pk_bf16_f32 v80, v48, v49
    v_fma_f32 v74, v74, s90, s90
    v_rcp_f32 v73, v73
    s_waitcnt vmcnt(40)
    v_mfma_f32_32x32x16_bf16 v[24:39], a[212:215], v[16:19], v[24:39]
    v_mul_f32 v51, v51, v71
    v_fma_f32 v75, v75, s90, s90
    v_rcp_f32 v74, v74
    v_mul_f32 v52, v52, v72
    s_waitcnt lgkmcnt(2)
    s_waitcnt vmcnt(39)
    v_mfma_f32_32x32x16_bf16 v[24:39], a[216:219], v[20:23], v[24:39]
    ds_read_b128 v[12:15], v3 offset:5120
    ds_read_b128 v[16:19], v3 offset:7168
    v_cvt_pk_bf16_f32 v81, v50, v51
    v_rcp_f32 v75, v75
    v_mul_f32 v53, v53, v73
    s_waitcnt vmcnt(38)
    v_mfma_f32_32x32x16_bf16 v[24:39], a[220:223], v[56:59], v[24:39]
    buffer_load_dwordx4 v[144:147], v2, s[36:39], s79 offen offset:2048 sc1
    v_mul_f32 v54, v54, v74
    v_cvt_pk_bf16_f32 v82, v52, v53
    v_mul_f32 v55, v55, v75
    v_cvt_pk_bf16_f32 v83, v54, v55
    buffer_store_dwordx4 v[80:83], v3, s[36:39], s89 offen offset:3072 sc1
    s_waitcnt lgkmcnt(2)
    v_mfma_f32_32x32x16_bf16 v[40:55], a[112:115], v[4:7], 0
    ds_read_b128 v[20:23], v3 offset:9216
    ds_read_b128 v[56:59], v3 offset:11264
    v_mfma_f32_32x32x16_bf16 v[40:55], a[116:119], v[8:11], v[40:55]
    buffer_load_dwordx4 v[148:151], v253, s[36:39], s79 offen offset:2048 sc1
    s_waitcnt lgkmcnt(2)
    v_mfma_f32_32x32x16_bf16 v[40:55], a[120:123], v[12:15], v[40:55]
    ds_read_b128 v[4:7], v3 offset:13312
    ds_read_b128 v[8:11], v3 offset:15360
    v_exp_f32 v68, -v24
    v_exp_f32 v69, -v25
    v_mfma_f32_32x32x16_bf16 v[40:55], a[124:127], v[16:19], v[40:55]
    v_exp_f32 v70, -v26
    v_fma_f32 v68, v68, s90, s90
    v_exp_f32 v71, -v27
    s_waitcnt lgkmcnt(2)
    v_mfma_f32_32x32x16_bf16 v[40:55], a[128:131], v[20:23], v[40:55]
    ds_read_b128 v[12:15], v3 offset:17408
    ds_read_b128 v[16:19], v3 offset:19456
    v_fma_f32 v69, v69, s90, s90
    v_rcp_f32 v68, v68
    v_mfma_f32_32x32x16_bf16 v[40:55], a[132:135], v[56:59], v[40:55]
    s_add_u32 s79, s79, 4096
    buffer_load_dwordx4 v[152:155], v2, s[36:39], s79 offen offset:0 sc1
    v_exp_f32 v72, -v28
    v_fma_f32 v70, v70, s90, s90
    s_waitcnt lgkmcnt(2)
    v_mfma_f32_32x32x16_bf16 v[40:55], a[136:139], v[4:7], v[40:55]
    ds_read_b128 v[20:23], v3 offset:21504
    ds_read_b128 v[56:59], v3 offset:23552
    v_rcp_f32 v69, v69
    v_exp_f32 v73, -v29
    v_mfma_f32_32x32x16_bf16 v[40:55], a[140:143], v[8:11], v[40:55]
    buffer_load_dwordx4 v[156:159], v253, s[36:39], s79 offen offset:0 sc1
    v_fma_f32 v71, v71, s90, s90
    v_rcp_f32 v70, v70
    v_mul_f32 v24, v24, v68
    s_waitcnt lgkmcnt(2)
    v_mfma_f32_32x32x16_bf16 v[40:55], a[144:147], v[12:15], v[40:55]
    ds_read_b128 v[4:7], v3 offset:25600
    ds_read_b128 v[8:11], v3 offset:27648
    v_exp_f32 v74, -v30
    v_fma_f32 v72, v72, s90, s90
    v_mfma_f32_32x32x16_bf16 v[40:55], a[148:151], v[16:19], v[40:55]
    v_rcp_f32 v71, v71
    v_mul_f32 v25, v25, v69
    v_exp_f32 v75, -v31
    s_waitcnt lgkmcnt(2)
    v_mfma_f32_32x32x16_bf16 v[40:55], a[152:155], v[20:23], v[40:55]
    ds_read_b128 v[12:15], v3 offset:29696
    ds_read_b128 v[16:19], v3 offset:31744
    v_fma_f32 v73, v73, s90, s90
    v_rcp_f32 v72, v72
    v_mul_f32 v26, v26, v70
    v_mfma_f32_32x32x16_bf16 v[40:55], a[156:159], v[56:59], v[40:55]
    buffer_load_dwordx4 v[160:163], v2, s[36:39], s79 offen offset:2048 sc1
    v_cvt_pk_bf16_f32 v76, v24, v25
    v_exp_f32 v68, -v32
    v_fma_f32 v74, v74, s90, s90
    s_waitcnt lgkmcnt(2)
    v_mfma_f32_32x32x16_bf16 v[40:55], a[160:163], v[4:7], v[40:55]
    ds_read_b128 v[20:23], v3 offset:33792
    ds_read_b128 v[56:59], v3 offset:35840
    v_rcp_f32 v73, v73
    v_mul_f32 v27, v27, v71
    v_mfma_f32_32x32x16_bf16 v[40:55], a[164:167], v[8:11], v[40:55]
    buffer_load_dwordx4 v[164:167], v253, s[36:39], s79 offen offset:2048 sc1
    v_exp_f32 v69, -v33
    v_fma_f32 v75, v75, s90, s90
    s_waitcnt lgkmcnt(2)
    v_mfma_f32_32x32x16_bf16 v[40:55], a[168:171], v[12:15], v[40:55]
    ds_read_b128 v[4:7], v3 offset:37888
    ds_read_b128 v[8:11], v3 offset:39936
    v_rcp_f32 v74, v74
    v_mul_f32 v28, v28, v72
    v_cvt_pk_bf16_f32 v77, v26, v27
    v_mfma_f32_32x32x16_bf16 v[40:55], a[172:175], v[16:19], v[40:55]
    v_exp_f32 v70, -v34
    v_fma_f32 v68, v68, s90, s90
    v_rcp_f32 v75, v75
    s_waitcnt lgkmcnt(2)
    v_mfma_f32_32x32x16_bf16 v[40:55], a[176:179], v[20:23], v[40:55]
    ds_read_b128 v[12:15], v3 offset:41984
    ds_read_b128 v[16:19], v3 offset:44032
    v_mul_f32 v29, v29, v73
    v_exp_f32 v71, -v35
    v_fma_f32 v69, v69, s90, s90
    v_mfma_f32_32x32x16_bf16 v[40:55], a[180:183], v[56:59], v[40:55]
    s_add_u32 s79, s79, 4096
    buffer_load_dwordx4 v[168:171], v2, s[36:39], s79 offen offset:0 sc1
    v_rcp_f32 v68, v68
    v_mul_f32 v30, v30, v74
    v_cvt_pk_bf16_f32 v78, v28, v29
    s_waitcnt lgkmcnt(2)
    v_mfma_f32_32x32x16_bf16 v[40:55], a[184:187], v[4:7], v[40:55]
    ds_read_b128 v[20:23], v3 offset:46080
    ds_read_b128 v[56:59], v3 offset:48128
    v_exp_f32 v72, -v36
    v_fma_f32 v70, v70, s90, s90
    v_mfma_f32_32x32x16_bf16 v[40:55], a[188:191], v[8:11], v[40:55]
    buffer_load_dwordx4 v[172:175], v253, s[36:39], s79 offen offset:0 sc1
    v_rcp_f32 v69, v69
    v_mul_f32 v31, v31, v75
    s_waitcnt lgkmcnt(2)
    v_mfma_f32_32x32x16_bf16 v[40:55], a[192:195], v[12:15], v[40:55]
    ds_read_b128 v[4:7], v3 offset:50176
    ds_read_b128 v[8:11], v3 offset:52224
    v_exp_f32 v73, -v37
    v_fma_f32 v71, v71, s90, s90
    v_mfma_f32_32x32x16_bf16 v[40:55], a[196:199], v[16:19], v[40:55]
    v_rcp_f32 v70, v70
    v_mul_f32 v32, v32, v68
    v_cvt_pk_bf16_f32 v79, v30, v31
    buffer_store_dwordx4 v[76:79], v3, s[36:39], s91 offen offset:0 sc1
    s_waitcnt lgkmcnt(2)
    v_mfma_f32_32x32x16_bf16 v[40:55], a[200:203], v[20:23], v[40:55]
    ds_read_b128 v[12:15], v3 offset:54272
    ds_read_b128 v[16:19], v3 offset:56320
    v_exp_f32 v74, -v38
    v_fma_f32 v72, v72, s90, s90
    v_rcp_f32 v71, v71
    v_mfma_f32_32x32x16_bf16 v[40:55], a[204:207], v[56:59], v[40:55]
    buffer_load_dwordx4 v[176:179], v2, s[36:39], s79 offen offset:2048 sc1
    v_mul_f32 v33, v33, v69
    v_exp_f32 v75, -v39
    v_fma_f32 v73, v73, s90, s90
    v_rcp_f32 v72, v72
    s_waitcnt lgkmcnt(2)
    v_mfma_f32_32x32x16_bf16 v[40:55], a[208:211], v[4:7], v[40:55]
    v_mul_f32 v34, v34, v70
    v_cvt_pk_bf16_f32 v80, v32, v33
    v_fma_f32 v74, v74, s90, s90
    v_rcp_f32 v73, v73
    v_mul_f32 v35, v35, v71
    v_mfma_f32_32x32x16_bf16 v[40:55], a[212:215], v[8:11], v[40:55]
    buffer_load_dwordx4 v[180:183], v253, s[36:39], s79 offen offset:2048 sc1
    v_fma_f32 v75, v75, s90, s90
    v_rcp_f32 v74, v74
    v_mul_f32 v36, v36, v72
    s_waitcnt lgkmcnt(0)
    v_mfma_f32_32x32x16_bf16 v[40:55], a[216:219], v[12:15], v[40:55]
    v_cvt_pk_bf16_f32 v81, v34, v35
    v_rcp_f32 v75, v75
    v_mul_f32 v37, v37, v73
    v_mul_f32 v38, v38, v74
    v_cvt_pk_bf16_f32 v82, v36, v37
    v_mfma_f32_32x32x16_bf16 v[40:55], a[220:223], v[16:19], v[40:55]
    s_add_u32 s79, s79, 4096
    buffer_load_dwordx4 v[184:187], v2, s[36:39], s79 offen offset:0 sc1
    v_mul_f32 v39, v39, v75
    v_cvt_pk_bf16_f32 v83, v38, v39
    buffer_store_dwordx4 v[80:83], v3, s[36:39], s91 offen offset:2048 sc1
    s_nop 6
    v_exp_f32 v68, -v40
    v_exp_f32 v69, -v41
    v_exp_f32 v70, -v42
    v_fma_f32 v68, v68, s90, s90
    v_exp_f32 v71, -v43
    v_fma_f32 v69, v69, s90, s90
    v_rcp_f32 v68, v68
    v_exp_f32 v72, -v44
    v_fma_f32 v70, v70, s90, s90
    v_rcp_f32 v69, v69
    v_exp_f32 v73, -v45
    v_fma_f32 v71, v71, s90, s90
    v_rcp_f32 v70, v70
    v_mul_f32 v40, v40, v68
    v_exp_f32 v74, -v46
    v_fma_f32 v72, v72, s90, s90
    v_rcp_f32 v71, v71
    v_mul_f32 v41, v41, v69
    v_exp_f32 v75, -v47
    v_fma_f32 v73, v73, s90, s90
    v_rcp_f32 v72, v72
    v_mul_f32 v42, v42, v70
    v_cvt_pk_bf16_f32 v76, v40, v41
    v_exp_f32 v68, -v48
    v_fma_f32 v74, v74, s90, s90
    v_rcp_f32 v73, v73
    v_mul_f32 v43, v43, v71
    v_exp_f32 v69, -v49
    v_fma_f32 v75, v75, s90, s90
    v_rcp_f32 v74, v74
    v_mul_f32 v44, v44, v72
    v_cvt_pk_bf16_f32 v77, v42, v43
    v_exp_f32 v70, -v50
    v_fma_f32 v68, v68, s90, s90
    v_rcp_f32 v75, v75
    v_mul_f32 v45, v45, v73
    v_exp_f32 v71, -v51
    v_fma_f32 v69, v69, s90, s90
    v_rcp_f32 v68, v68
    v_mul_f32 v46, v46, v74
    v_cvt_pk_bf16_f32 v78, v44, v45
    v_exp_f32 v72, -v52
    v_fma_f32 v70, v70, s90, s90
    v_rcp_f32 v69, v69
    v_mul_f32 v47, v47, v75
    v_exp_f32 v73, -v53
    v_fma_f32 v71, v71, s90, s90
    v_rcp_f32 v70, v70
    v_mul_f32 v48, v48, v68
    v_cvt_pk_bf16_f32 v79, v46, v47
    buffer_store_dwordx4 v[76:79], v3, s[36:39], s91 offen offset:1024 sc1
    v_exp_f32 v74, -v54
    v_fma_f32 v72, v72, s90, s90
    v_rcp_f32 v71, v71
    v_mul_f32 v49, v49, v69
    v_exp_f32 v75, -v55
    v_fma_f32 v73, v73, s90, s90
    v_rcp_f32 v72, v72
    v_mul_f32 v50, v50, v70
    v_cvt_pk_bf16_f32 v80, v48, v49
    v_fma_f32 v74, v74, s90, s90
    v_rcp_f32 v73, v73
    v_mul_f32 v51, v51, v71
    v_fma_f32 v75, v75, s90, s90
    v_rcp_f32 v74, v74
    v_mul_f32 v52, v52, v72
    v_cvt_pk_bf16_f32 v81, v50, v51
    v_rcp_f32 v75, v75
    v_mul_f32 v53, v53, v73
    v_mul_f32 v54, v54, v74
    v_cvt_pk_bf16_f32 v82, v52, v53
    v_mul_f32 v55, v55, v75
    v_cvt_pk_bf16_f32 v83, v54, v55
    buffer_store_dwordx4 v[80:83], v3, s[36:39], s91 offen offset:3072 sc1
    s_waitcnt vmcnt(0)
    s_barrier
    s_lshl_b32 s57, s4, 3
    s_add_u32 s57, s57, s5
    s_lshl_b32 s57, s57, 7
    s_add_u32 s57, s57, 106496
    s_cmp_lg_u32 s6, 0
    s_cbranch_scc1 L_fl_19
    v_mov_b32 v252, s56
    v_mov_b32 v254, s57
    s_mov_b64 exec, 1
    buffer_store_dword v252, v254, s[36:39], 0 offen sc1
    s_mov_b64 exec, -1
L_fl_19:
    buffer_load_dwordx4 v[188:191], v253, s[36:39], s79 offen offset:0 sc1
    buffer_load_dwordx4 v[192:195], v2, s[36:39], s79 offen offset:2048 sc1
    buffer_load_dwordx4 v[196:199], v253, s[36:39], s79 offen offset:2048 sc1
    s_add_u32 s79, s79, 24576
    buffer_load_dwordx4 a[0:3], v253, s[36:39], s79 offen offset:0 sc1
    buffer_load_dwordx4 a[4:7], v2, s[36:39], s79 offen offset:2048 sc1
    buffer_load_dwordx4 a[8:11], v253, s[36:39], s79 offen offset:2048 sc1
    s_add_u32 s79, s79, 4096
    buffer_load_dwordx4 a[12:15], v2, s[36:39], s79 offen offset:0 sc1
    buffer_load_dwordx4 a[16:19], v253, s[36:39], s79 offen offset:0 sc1
    buffer_load_dwordx4 a[20:23], v2, s[36:39], s79 offen offset:2048 sc1
    buffer_load_dwordx4 a[24:27], v253, s[36:39], s79 offen offset:2048 sc1
    v_min_u32 v2, 6, v1
    s_lshl_b32 s57, s4, 3
    v_add_u32 v2, s57, v2
    v_lshlrev_b32 v2, 7, v2
    v_add_u32 v2, 106496, v2
    s_mov_b32 s96, 0
L_poll_20:
    buffer_load_dword v6, v2, s[36:39], 0 offen sc1
    s_waitcnt vmcnt(0)
    v_cmp_ne_u32 vcc, s56, v6
    s_add_u32 s96, s96, 1
    s_nop 3
    s_cmp_eq_u64 vcc, 0
    s_cbranch_scc1 L_polld_21
    s_mov_b64 exec, vcc
    s_cmp_lt_u32 s96, 131072
    s_cbranch_scc1 L_poll_20
L_polld_21:
    s_mov_b64 exec, -1
    s_mul_i32 s57, s4, 112
    s_mul_i32 s58, s6, 28
    s_add_u32 s57, s57, s58
    s_lshl_b32 s84, s57, 11
    s_add_u32 s84, s84, 9060352
    s_and_b32 s57, s6, 1
    s_mul_i32 s57, s57, 1024
    v_add_u32 v4, s57, v3
    s_sub_u32 s57, 1024, s57
    v_add_u32 v5, s57, v3
    buffer_load_dwordx4 a[28:31], v4, s[36:39], s84 offen offset:0 sc1
    buffer_load_dwordx4 a[32:35], v5, s[36:39], s84 offen offset:0 sc1
    buffer_load_dwordx4 a[36:39], v4, s[36:39], s84 offen offset:2048 sc1
    buffer_load_dwordx4 a[40:43], v5, s[36:39], s84 offen offset:2048 sc1
    s_add_u32 s84, s84, 4096
    buffer_load_dwordx4 a[44:47], v4, s[36:39], s84 offen offset:0 sc1
    buffer_load_dwordx4 a[48:51], v5, s[36:39], s84 offen offset:0 sc1
    buffer_load_dwordx4 a[52:55], v4, s[36:39], s84 offen offset:2048 sc1
    buffer_load_dwordx4 a[56:59], v5, s[36:39], s84 offen offset:2048 sc1
    s_add_u32 s84, s84, 4096
    buffer_load_dwordx4 a[60:63], v4, s[36:39], s84 offen offset:0 sc1
    buffer_load_dwordx4 a[64:67], v5, s[36:39], s84 offen offset:0 sc1
    buffer_load_dwordx4 a[68:71], v4, s[36:39], s84 offen offset:2048 sc1
    buffer_load_dwordx4 a[72:75], v5, s[36:39], s84 offen offset:2048 sc1
    s_xor_b32 s57, s6, 1
    s_mul_i32 s57, s57, 12288
    s_add_u32 s57, s57, 0
    v_add_u32 v8, s57, v3
    s_xor_b32 s57, s6, 2
    s_mul_i32 s57, s57, 12288
    s_add_u32 s57, s57, 4096
    v_add_u32 v9, s57, v3
    s_xor_b32 s57, s6, 3
    s_mul_i32 s57, s57, 12288
    s_add_u32 s57, s57, 8192
    v_add_u32 v10, s57, v3
    s_mul_i32 s57, s6, 12288
    s_add_u32 s57, s57, 0
    v_add_u32 v11, s57, v3
    s_lshr_b32 s57, s6, 1
    s_and_b32 s58, s6, 1
    v_lshrrev_b32 v15, 5, v1
    s_lshl_b32 s59, s57, 7
    s_add_u32 s59, s59, 137728
    v_lshl_add_u32 v12, v15, 4, s59
    s_lshl_b32 s59, s5, 13
    s_lshl_b32 s60, s57, 12
    s_add_u32 s59, s59, s60
    s_lshl_b32 s60, s58, 7
    s_add_u32 s59, s59, s60
    s_add_u32 s59, s59, 69632
    v_lshl_add_u32 v13, v15, 9, s59
    v_and_b32 v14, 31, v1
    v_lshl_add_u32 v13, v14, 2, v13
    s_lshl_b32 s59, s4, 6
    s_lshl_b32 s60, s58, 5
    s_add_u32 s59, s59, s60
    v_add_u32 v14, s59, v14
    v_mul_u32_u24 v14, 896, v14
    s_lshl_b32 s59, s5, 7
    s_lshl_b32 s60, s57, 6
    s_add_u32 s59, s59, s60
    v_lshl_add_u32 v15, v15, 4, s59
    v_add_u32 v14, v14, v15
    s_mov_b32 s40, s30
    s_mov_b32 s41, s31
    s_mov_b32 s42, 1835008
    s_mov_b32 s43, 0x00020000
    s_add_u32 s84, s84, 4096
    buffer_load_dwordx4 a[76:79], v4, s[36:39], s84 offen offset:0 sc1
    buffer_load_dwordx4 a[80:83], v5, s[36:39], s84 offen offset:0 sc1
    s_waitcnt vmcnt(13)
    v_mfma_f32_32x32x16_bf16 v[24:39], v[88:91], a[28:31], 0
    v_mfma_f32_32x32x16_bf16 v[56:71], v[92:95], a[28:31], 0
    s_waitcnt vmcnt(12)
    v_mfma_f32_32x32x16_bf16 v[40:55], v[88:91], a[32:35], 0
    v_mfma_f32_32x32x16_bf16 v[72:87], v[92:95], a[32:35], 0
    buffer_load_dwordx4 a[84:87], v4, s[36:39], s84 offen offset:2048 sc1
    buffer_load_dwordx4 a[88:91], v5, s[36:39], s84 offen offset:2048 sc1
    s_waitcnt vmcnt(13)
    v_mfma_f32_32x32x16_bf16 v[24:39], v[96:99], a[36:39], v[24:39]
    v_mfma_f32_32x32x16_bf16 v[56:71], v[100:103], a[36:39], v[56:71]
    s_waitcnt vmcnt(12)
    v_mfma_f32_32x32x16_bf16 v[40:55], v[96:99], a[40:43], v[40:55]
    v_mfma_f32_32x32x16_bf16 v[72:87], v[100:103], a[40:43], v[72:87]
    s_add_u32 s84, s84, 4096
    buffer_load_dwordx4 a[92:95], v4, s[36:39], s84 offen offset:0 sc1
    buffer_load_dwordx4 a[96:99], v5, s[36:39], s84 offen offset:0 sc1
    s_waitcnt vmcnt(13)
    v_mfma_f32_32x32x16_bf16 v[24:39], v[104:107], a[44:47], v[24:39]
    v_mfma_f32_32x32x16_bf16 v[56:71], v[108:111], a[44:47], v[56:71]
    s_waitcnt vmcnt(12)
    v_mfma_f32_32x32x16_bf16 v[40:55], v[104:107], a[48:51], v[40:55]
    v_mfma_f32_32x32x16_bf16 v[72:87], v[108:111], a[48:51], v[72:87]
    buffer_load_dwordx4 a[100:103], v4, s[36:39], s84 offen offset:2048 sc1
    buffer_load_dwordx4 a[104:107], v5, s[36:39], s84 offen offset:2048 sc1
    s_waitcnt vmcnt(13)
    v_mfma_f32_32x32x16_bf16 v[24:39], v[112:115], a[52:55], v[24:39]
    v_mfma_f32_32x32x16_bf16 v[56:71], v[116:119], a[52:55], v[56:71]
    s_waitcnt vmcnt(12)
    v_mfma_f32_32x32x16_bf16 v[40:55], v[112:115], a[56:59], v[40:55]
    v_mfma_f32_32x32x16_bf16 v[72:87], v[116:119], a[56:59], v[72:87]
    s_add_u32 s84, s84, 4096
    buffer_load_dwordx4 a[108:111], v4, s[36:39], s84 offen offset:0 sc1
    buffer_load_dwordx4 a[112:115], v5, s[36:39], s84 offen offset:0 sc1
    s_waitcnt vmcnt(13)
    v_mfma_f32_32x32x16_bf16 v[24:39], v[120:123], a[60:63], v[24:39]
    v_mfma_f32_32x32x16_bf16 v[56:71], v[124:127], a[60:63], v[56:71]
    s_waitcnt vmcnt(12)
    v_mfma_f32_32x32x16_bf16 v[40:55], v[120:123], a[64:67], v[40:55]
    v_mfma_f32_32x32x16_bf16 v[72:87], v[124:127], a[64:67], v[72:87]
    buffer_load_dwordx4 a[116:119], v4, s[36:39], s84 offen offset:2048 sc1
    buffer_load_dwordx4 a[120:123], v5, s[36:39], s84 offen offset:2048 sc1
    s_waitcnt vmcnt(13)
    v_mfma_f32_32x32x16_bf16 v[24:39], v[128:131], a[68:71], v[24:39]
    v_mfma_f32_32x32x16_bf16 v[56:71], v[132:135], a[68:71], v[56:71]
    s_waitcnt vmcnt(12)
    v_mfma_f32_32x32x16_bf16 v[40:55], v[128:131], a[72:75], v[40:55]
    v_mfma_f32_32x32x16_bf16 v[72:87], v[132:135], a[72:75], v[72:87]
    s_add_u32 s84, s84, 4096
    buffer_load_dwordx4 a[124:127], v4, s[36:39], s84 offen offset:0 sc1
    buffer_load_dwordx4 a[128:131], v5, s[36:39], s84 offen offset:0 sc1
    s_waitcnt vmcnt(13)
    v_mfma_f32_32x32x16_bf16 v[24:39], v[136:139], a[76:79], v[24:39]
    v_mfma_f32_32x32x16_bf16 v[56:71], v[140:143], a[76:79], v[56:71]
    s_waitcnt vmcnt(12)
    v_mfma_f32_32x32x16_bf16 v[40:55], v[136:139], a[80:83], v[40:55]
    v_mfma_f32_32x32x16_bf16 v[72:87], v[140:143], a[80:83], v[72:87]
    buffer_load_dwordx4 a[132:135], v4, s[36:39], s84 offen offset:2048 sc1
    buffer_load_dwordx4 a[136:139], v5, s[36:39], s84 offen offset:2048 sc1
    s_waitcnt vmcnt(13)
    v_mfma_f32_32x32x16_bf16 v[24:39], v[144:147], a[84:87], v[24:39]
    v_mfma_f32_32x32x16_bf16 v[56:71], v[148:151], a[84:87], v[56:71]
    s_waitcnt vmcnt(12)
    v_mfma_f32_32x32x16_bf16 v[40:55], v[144:147], a[88:91], v[40:55]
    v_mfma_f32_32x32x16_bf16 v[72:87], v[148:151], a[88:91], v[72:87]
    s_add_u32 s84, s84, 4096
    buffer_load_dwordx4 a[140:143], v4, s[36:39], s84 offen offset:0 sc1
    buffer_load_dwordx4 a[144:147], v5, s[36:39], s84 offen offset:0 sc1
    s_waitcnt vmcnt(13)
    v_mfma_f32_32x32x16_bf16 v[24:39], v[152:155], a[92:95], v[24:39]
    v_mfma_f32_32x32x16_bf16 v[56:71], v[156:159], a[92:95], v[56:71]
    s_waitcnt vmcnt(12)
    v_mfma_f32_32x32x16_bf16 v[40:55], v[152:155], a[96:99], v[40:55]
    v_mfma_f32_32x32x16_bf16 v[72:87], v[156:159], a[96:99], v[72:87]
    buffer_load_dwordx4 a[148:151], v4, s[36:39], s84 offen offset:2048 sc1
    buffer_load_dwordx4 a[152:155], v5, s[36:39], s84 offen offset:2048 sc1
    s_waitcnt vmcnt(13)
    v_mfma_f32_32x32x16_bf16 v[24:39], v[160:163], a[100:103], v[24:39]
    v_mfma_f32_32x32x16_bf16 v[56:71], v[164:167], a[100:103], v[56:71]
    s_waitcnt vmcnt(12)
    v_mfma_f32_32x32x16_bf16 v[40:55], v[160:163], a[104:107], v[40:55]
    v_mfma_f32_32x32x16_bf16 v[72:87], v[164:167], a[104:107], v[72:87]
    s_add_u32 s84, s84, 4096
    buffer_load_dwordx4 a[156:159], v4, s[36:39], s84 offen offset:0 sc1
    buffer_load_dwordx4 a[160:163], v5, s[36:39], s84 offen offset:0 sc1
    s_waitcnt vmcnt(13)
    v_mfma_f32_32x32x16_bf16 v[24:39], v[168:171], a[108:111], v[24:39]
    v_mfma_f32_32x32x16_bf16 v[56:71], v[172:175], a[108:111], v[56:71]
    s_waitcnt vmcnt(12)
    v_mfma_f32_32x32x16_bf16 v[40:55], v[168:171], a[112:115], v[40:55]
    v_mfma_f32_32x32x16_bf16 v[72:87], v[172:175], a[112:115], v[72:87]
    buffer_load_dwordx4 a[164:167], v4, s[36:39], s84 offen offset:2048 sc1
    buffer_load_dwordx4 a[168:171], v5, s[36:39], s84 offen offset:2048 sc1
    s_waitcnt vmcnt(13)
    v_mfma_f32_32x32x16_bf16 v[24:39], v[176:179], a[116:119], v[24:39]
    v_mfma_f32_32x32x16_bf16 v[56:71], v[180:183], a[116:119], v[56:71]
    s_waitcnt vmcnt(12)
    v_mfma_f32_32x32x16_bf16 v[40:55], v[176:179], a[120:123], v[40:55]
    v_mfma_f32_32x32x16_bf16 v[72:87], v[180:183], a[120:123], v[72:87]
    s_add_u32 s84, s84, 4096
    buffer_load_dwordx4 a[172:175], v4, s[36:39], s84 offen offset:0 sc1
    buffer_load_dwordx4 a[176:179], v5, s[36:39], s84 offen offset:0 sc1
    s_waitcnt vmcnt(13)
    v_mfma_f32_32x32x16_bf16 v[24:39], v[184:187], a[124:127], v[24:39]
    v_mfma_f32_32x32x16_bf16 v[56:71], v[188:191], a[124:127], v[56:71]
    s_waitcnt vmcnt(12)
    v_mfma_f32_32x32x16_bf16 v[40:55], v[184:187], a[128:131], v[40:55]
    v_mfma_f32_32x32x16_bf16 v[72:87], v[188:191], a[128:131], v[72:87]
    buffer_load_dwordx4 a[180:183], v4, s[36:39], s84 offen offset:2048 sc1
    buffer_load_dwordx4 a[184:187], v5, s[36:39], s84 offen offset:2048 sc1
    s_waitcnt vmcnt(13)
    v_mfma_f32_32x32x16_bf16 v[24:39], v[192:195], a[132:135], v[24:39]
    v_mfma_f32_32x32x16_bf16 v[56:71], v[196:199], a[132:135], v[56:71]
    s_waitcnt vmcnt(12)
    v_mfma_f32_32x32x16_bf16 v[40:55], v[192:195], a[136:139], v[40:55]
    v_mfma_f32_32x32x16_bf16 v[72:87], v[196:199], a[136:139], v[72:87]
    s_add_u32 s84, s84, 4096
    buffer_load_dwordx4 a[188:191], v4, s[36:39], s84 offen offset:0 sc1
    buffer_load_dwordx4 a[192:195], v5, s[36:39], s84 offen offset:0 sc1
    s_waitcnt vmcnt(13)
    v_mfma_f32_32x32x16_bf16 v[24:39], v[200:203], a[140:143], v[24:39]
    v_mfma_f32_32x32x16_bf16 v[56:71], v[204:207], a[140:143], v[56:71]
    s_waitcnt vmcnt(12)
    v_mfma_f32_32x32x16_bf16 v[40:55], v[200:203], a[144:147], v[40:55]
    v_mfma_f32_32x32x16_bf16 v[72:87], v[204:207], a[144:147], v[72:87]
    buffer_load_dwordx4 a[196:199], v4, s[36:39], s84 offen offset:2048 sc1
    buffer_load_dwordx4 a[200:203], v5, s[36:39], s84 offen offset:2048 sc1
    s_waitcnt vmcnt(13)
    v_mfma_f32_32x32x16_bf16 v[24:39], v[208:211], a[148:151], v[24:39]
    v_mfma_f32_32x32x16_bf16 v[56:71], v[212:215], a[148:151], v[56:71]
    s_waitcnt vmcnt(12)
    v_mfma_f32_32x32x16_bf16 v[40:55], v[208:211], a[152:155], v[40:55]
    v_mfma_f32_32x32x16_bf16 v[72:87], v[212:215], a[152:155], v[72:87]
    s_add_u32 s84, s84, 4096
    buffer_load_dwordx4 a[204:207], v4, s[36:39], s84 offen offset:0 sc1
    buffer_load_dwordx4 a[208:211], v5, s[36:39], s84 offen offset:0 sc1
    s_waitcnt vmcnt(13)
    v_mfma_f32_32x32x16_bf16 v[24:39], v[216:219], a[156:159], v[24:39]
    v_mfma_f32_32x32x16_bf16 v[56:71], v[220:223], a[156:159], v[56:71]
    s_waitcnt vmcnt(12)
    v_mfma_f32_32x32x16_bf16 v[40:55], v[216:219], a[160:163], v[40:55]
    v_mfma_f32_32x32x16_bf16 v[72:87], v[220:223], a[160:163], v[72:87]
    buffer_load_dwordx4 a[212:215], v4, s[36:39], s84 offen offset:2048 sc1
    buffer_load_dwordx4 a[216:219], v5, s[36:39], s84 offen offset:2048 sc1
    s_waitcnt vmcnt(13)
    v_mfma_f32_32x32x16_bf16 v[24:39], v[224:227], a[164:167], v[24:39]
    v_mfma_f32_32x32x16_bf16 v[56:71], v[228:231], a[164:167], v[56:71]
    s_waitcnt vmcnt(12)
    v_mfma_f32_32x32x16_bf16 v[40:55], v[224:227], a[168:171], v[40:55]
    v_mfma_f32_32x32x16_bf16 v[72:87], v[228:231], a[168:171], v[72:87]
    s_add_u32 s84, s84, 4096
    buffer_load_dwordx4 a[220:223], v4, s[36:39], s84 offen offset:0 sc1
    buffer_load_dwordx4 a[28:31], v5, s[36:39], s84 offen offset:0 sc1
    s_waitcnt vmcnt(13)
    v_mfma_f32_32x32x16_bf16 v[24:39], v[232:235], a[172:175], v[24:39]
    v_mfma_f32_32x32x16_bf16 v[56:71], v[236:239], a[172:175], v[56:71]
    s_waitcnt vmcnt(12)
    v_mfma_f32_32x32x16_bf16 v[40:55], v[232:235], a[176:179], v[40:55]
    v_mfma_f32_32x32x16_bf16 v[72:87], v[236:239], a[176:179], v[72:87]
    buffer_load_dwordx4 a[32:35], v4, s[36:39], s84 offen offset:2048 sc1
    buffer_load_dwordx4 a[36:39], v5, s[36:39], s84 offen offset:2048 sc1
    s_waitcnt vmcnt(13)
    v_mfma_f32_32x32x16_bf16 v[24:39], v[240:243], a[180:183], v[24:39]
    v_mfma_f32_32x32x16_bf16 v[56:71], v[244:247], a[180:183], v[56:71]
    s_waitcnt vmcnt(12)
    v_mfma_f32_32x32x16_bf16 v[40:55], v[240:243], a[184:187], v[40:55]
    v_mfma_f32_32x32x16_bf16 v[72:87], v[244:247], a[184:187], v[72:87]
    s_add_u32 s84, s84, 4096
    buffer_load_dwordx4 a[40:43], v4, s[36:39], s84 offen offset:0 sc1
    buffer_load_dwordx4 a[44:47], v5, s[36:39], s84 offen offset:0 sc1
    s_waitcnt vmcnt(13)
    v_mfma_f32_32x32x16_bf16 v[24:39], v[248:251], a[188:191], v[24:39]
    v_mfma_f32_32x32x16_bf16 v[56:71], a[224:227], a[188:191], v[56:71]
    s_waitcnt vmcnt(12)
    v_mfma_f32_32x32x16_bf16 v[40:55], v[248:251], a[192:195], v[40:55]
    v_mfma_f32_32x32x16_bf16 v[72:87], a[224:227], a[192:195], v[72:87]
    buffer_load_dwordx4 a[48:51], v4, s[36:39], s84 offen offset:2048 sc1
    buffer_load_dwordx4 a[52:55], v5, s[36:39], s84 offen offset:2048 sc1
    s_waitcnt vmcnt(13)
    v_mfma_f32_32x32x16_bf16 v[24:39], a[228:231], a[196:199], v[24:39]
    v_mfma_f32_32x32x16_bf16 v[56:71], a[232:235], a[196:199], v[56:71]
    s_waitcnt vmcnt(12)
    v_mfma_f32_32x32x16_bf16 v[40:55], a[228:231], a[200:203], v[40:55]
    v_mfma_f32_32x32x16_bf16 v[72:87], a[232:235], a[200:203], v[72:87]
    s_waitcnt vmcnt(11)
    v_mfma_f32_32x32x16_bf16 v[56:71], a[240:243], a[204:207], v[56:71]
    s_waitcnt vmcnt(10)
    v_mfma_f32_32x32x16_bf16 v[40:55], a[236:239], a[208:211], v[40:55]
    v_mfma_f32_32x32x16_bf16 v[72:87], a[240:243], a[208:211], v[72:87]
    s_waitcnt vmcnt(9)
    v_mfma_f32_32x32x16_bf16 v[56:71], a[248:251], a[212:215], v[56:71]
    s_waitcnt vmcnt(8)
    v_mfma_f32_32x32x16_bf16 v[40:55], a[244:247], a[216:219], v[40:55]
    v_mfma_f32_32x32x16_bf16 v[72:87], a[248:251], a[216:219], v[72:87]
    s_waitcnt vmcnt(7)
    v_mfma_f32_32x32x16_bf16 v[56:71], a[0:3], a[220:223], v[56:71]
    s_waitcnt vmcnt(6)
    v_mfma_f32_32x32x16_bf16 v[40:55], a[252:255], a[28:31], v[40:55]
    v_mfma_f32_32x32x16_bf16 v[72:87], a[0:3], a[28:31], v[72:87]
    s_waitcnt vmcnt(5)
    v_mfma_f32_32x32x16_bf16 v[56:71], a[8:11], a[32:35], v[56:71]
    s_waitcnt vmcnt(4)
    v_mfma_f32_32x32x16_bf16 v[40:55], a[4:7], a[36:39], v[40:55]
    v_mfma_f32_32x32x16_bf16 v[72:87], a[8:11], a[36:39], v[72:87]
    s_waitcnt vmcnt(3)
    v_mfma_f32_32x32x16_bf16 v[56:71], a[16:19], a[40:43], v[56:71]
    s_waitcnt vmcnt(2)
    v_mfma_f32_32x32x16_bf16 v[40:55], a[12:15], a[44:47], v[40:55]
    v_mfma_f32_32x32x16_bf16 v[72:87], a[16:19], a[44:47], v[72:87]
    s_waitcnt vmcnt(1)
    v_mfma_f32_32x32x16_bf16 v[56:71], a[24:27], a[48:51], v[56:71]
    s_waitcnt vmcnt(0)
    v_mfma_f32_32x32x16_bf16 v[40:55], a[20:23], a[52:55], v[40:55]
    v_mfma_f32_32x32x16_bf16 v[72:87], a[24:27], a[52:55], v[72:87]
    ds_read_b128 v[104:107], v12 offset:0
    ds_read2st64_b32 v[120:121], v13 offset0:0 offset1:1
    ds_read_b128 v[108:111], v12 offset:32
    ds_read2st64_b32 v[122:123], v13 offset0:4 offset1:5
    ds_read_b128 v[112:115], v12 offset:64
    ds_read2st64_b32 v[124:125], v13 offset0:8 offset1:9
    ds_read_b128 v[116:119], v12 offset:96
    ds_read2st64_b32 v[126:127], v13 offset0:12 offset1:13
    v_mfma_f32_32x32x16_bf16 v[24:39], a[236:239], a[204:207], v[24:39]
    s_nop 1
    ds_write_b128 v8, v[40:43] offset:0
    ds_write_b128 v8, v[44:47] offset:1024
    v_mfma_f32_32x32x16_bf16 v[24:39], a[244:247], a[212:215], v[24:39]
    ds_write_b128 v8, v[48:51] offset:2048
    ds_write_b128 v8, v[52:55] offset:3072
    v_mfma_f32_32x32x16_bf16 v[24:39], a[252:255], a[220:223], v[24:39]
    ds_write_b128 v9, v[56:59] offset:0
    ds_write_b128 v9, v[60:63] offset:1024
    v_mfma_f32_32x32x16_bf16 v[24:39], a[4:7], a[32:35], v[24:39]
    ds_write_b128 v9, v[64:67] offset:2048
    ds_write_b128 v9, v[68:71] offset:3072
    v_mfma_f32_32x32x16_bf16 v[24:39], a[12:15], a[40:43], v[24:39]
    ds_write_b128 v10, v[72:75] offset:0
    ds_write_b128 v10, v[76:79] offset:1024
    v_mfma_f32_32x32x16_bf16 v[24:39], a[20:23], a[48:51], v[24:39]
    ds_write_b128 v10, v[80:83] offset:2048
    ds_write_b128 v10, v[84:87] offset:3072
    v_lshlrev_b32 v128, 16, v120
    v_and_b32 v129, s80, v120
    v_lshlrev_b32 v130, 16, v121
    v_and_b32 v131, s80, v121
    v_lshlrev_b32 v132, 16, v122
    v_and_b32 v133, s80, v122
    v_lshlrev_b32 v134, 16, v123
    v_and_b32 v135, s80, v123
    s_waitcnt lgkmcnt(14)
    v_lshlrev_b32 v136, 16, v124
    v_and_b32 v137, s80, v124
    v_lshlrev_b32 v138, 16, v125
    v_and_b32 v139, s80, v125
    s_waitcnt lgkmcnt(12)
    v_lshlrev_b32 v140, 16, v126
    v_and_b32 v141, s80, v126
    v_lshlrev_b32 v142, 16, v127
    v_and_b32 v143, s80, v127
    s_waitcnt lgkmcnt(0)
    s_barrier
    ds_read_b128 v[144:147], v11 offset:0
    ds_read_b128 v[148:151], v11 offset:1024
    ds_read_b128 v[152:155], v11 offset:2048
    ds_read_b128 v[156:159], v11 offset:3072
    ds_read_b128 v[160:163], v11 offset:4096
    ds_read_b128 v[164:167], v11 offset:5120
    ds_read_b128 v[168:171], v11 offset:6144
    ds_read_b128 v[172:175], v11 offset:7168
    ds_read_b128 v[176:179], v11 offset:8192
    ds_read_b128 v[180:183], v11 offset:9216
    ds_read_b128 v[184:187], v11 offset:10240
    ds_read_b128 v[188:191], v11 offset:11264
    s_waitcnt lgkmcnt(8)
    v_pk_add_f32 v[24:25], v[24:25], v[144:145]
    v_pk_add_f32 v[26:27], v[26:27], v[146:147]
    v_pk_add_f32 v[28:29], v[28:29], v[148:149]
    v_pk_add_f32 v[30:31], v[30:31], v[150:151]
    v_pk_add_f32 v[32:33], v[32:33], v[152:153]
    v_pk_add_f32 v[34:35], v[34:35], v[154:155]
    v_pk_add_f32 v[36:37], v[36:37], v[156:157]
    v_pk_add_f32 v[38:39], v[38:39], v[158:159]
    s_waitcnt lgkmcnt(4)
    v_pk_add_f32 v[24:25], v[24:25], v[160:161]
    v_pk_add_f32 v[26:27], v[26:27], v[162:163]
    v_pk_add_f32 v[28:29], v[28:29], v[164:165]
    v_pk_add_f32 v[30:31], v[30:31], v[166:167]
    v_pk_add_f32 v[32:33], v[32:33], v[168:169]
    v_pk_add_f32 v[34:35], v[34:35], v[170:171]
    v_pk_add_f32 v[36:37], v[36:37], v[172:173]
    v_pk_add_f32 v[38:39], v[38:39], v[174:175]
    s_waitcnt lgkmcnt(0)
    v_pk_add_f32 v[24:25], v[24:25], v[176:177]
    v_pk_add_f32 v[26:27], v[26:27], v[178:179]
    v_pk_add_f32 v[28:29], v[28:29], v[180:181]
    v_pk_add_f32 v[30:31], v[30:31], v[182:183]
    v_pk_add_f32 v[32:33], v[32:33], v[184:185]
    v_pk_add_f32 v[34:35], v[34:35], v[186:187]
    v_pk_add_f32 v[36:37], v[36:37], v[188:189]
    v_pk_add_f32 v[38:39], v[38:39], v[190:191]
    v_pk_fma_f32 v[24:25], v[24:25], v[104:105], v[128:129]
    v_pk_fma_f32 v[26:27], v[26:27], v[106:107], v[130:131]
    v_pk_fma_f32 v[28:29], v[28:29], v[108:109], v[132:133]
    v_pk_fma_f32 v[30:31], v[30:31], v[110:111], v[134:135]
    v_pk_fma_f32 v[32:33], v[32:33], v[112:113], v[136:137]
    v_pk_fma_f32 v[34:35], v[34:35], v[114:115], v[138:139]
    v_pk_fma_f32 v[36:37], v[36:37], v[116:117], v[140:141]
    v_pk_fma_f32 v[38:39], v[38:39], v[118:119], v[142:143]
    v_cvt_pk_bf16_f32 v192, v24, v25
    v_cvt_pk_bf16_f32 v193, v26, v27
    v_cvt_pk_bf16_f32 v194, v28, v29
    v_cvt_pk_bf16_f32 v195, v30, v31
    v_cvt_pk_bf16_f32 v196, v32, v33
    v_cvt_pk_bf16_f32 v197, v34, v35
    v_cvt_pk_bf16_f32 v198, v36, v37
    v_cvt_pk_bf16_f32 v199, v38, v39
    v_permlane32_swap_b32 v192, v194
    v_permlane32_swap_b32 v193, v195
    v_permlane32_swap_b32 v196, v198
    v_permlane32_swap_b32 v197, v199
    buffer_store_dwordx4 v[192:195], v14, s[40:43], 0 offen offset:0 nt
    buffer_store_dwordx4 v[196:199], v14, s[40:43], 0 offen offset:32 nt
    s_endpgm
L_exit:
    s_endpgm
L_code_end:
.section .rodata,"a"
.p2align 6
.amdhsa_kernel adaLN_cond__ssm_conv_h3__dense_activation_silu__prompt_kernel
  .amdhsa_next_free_vgpr 512
  .amdhsa_next_free_sgpr 102
  .amdhsa_accum_offset 256
  .amdhsa_group_segment_fixed_size 0
  .amdhsa_kernarg_size 112
  .amdhsa_user_sgpr_count 2
  .amdhsa_user_sgpr_kernarg_segment_ptr 1
  .amdhsa_system_sgpr_workgroup_id_x 1
  .amdhsa_float_denorm_mode_32 3
.end_amdhsa_kernel
```
